```python
import torch

def _softmax(x, axis=-1):
    return torch.softmax(x, dim=axis)
def _gelu(x):
    return torch.nn.functional.gelu(x, approximate="tanh")
def _silu(x):
    return torch.nn.functional.silu(x)
def _sigmoid(x):
    return torch.sigmoid(x)
def _layernorm(x, axis=-1, eps=1e-5):
    m = x.mean(dim=axis, keepdim=True)
    v = x.var(dim=axis, keepdim=True, unbiased=False)
    return (x - m) / torch.sqrt(v + eps)
def _scatter_add(tgt, idx, src, axis=0):
    return tgt.clone().index_add_(axis, idx, src)
def _segment_sum(src, seg, n):
    out = torch.zeros((n,) + src.shape[1:], dtype=src.dtype)
    return out.index_add_(0, seg, src)
def _pad(x, pw):
    flat = tuple(v for pair in reversed(pw) for v in pair)
    return torch.nn.functional.pad(x, flat)

kernel_name = 'standalone__kv_cache_quant_int4_int2_kv_with_per_channel_or_per_token_scales__prompt'

def setup_inputs():

    _w = (lambda a: (lambda t: t.to(torch.bfloat16) if t.is_floating_point() else t)(torch.as_tensor(a)))
    B = 1
    Sq = 2048
    Skv = 2048
    Hq = 32
    Hkv = 4
    Dh = 128
    bits = 3
    G = -1
    if G <= 0 or G >= Skv:
        G = max(1, Skv // 2)
    Skv = (Skv // G) * G
    ngk = Skv // G
    qmax = (1 << bits) - 1
    return {
        "q": _w((lambda *s: torch.randn(*s, dtype=torch.bfloat16) * 1.6)(B, Hq, Sq, Dh)),
        "qk": _w(torch.randint(0, qmax + 1, (B, Hkv, Skv, Dh)).to(torch.int32)),
        "qv": _w(torch.randint(0, qmax + 1, (B, Hkv, Skv, Dh)).to(torch.int32)),
        "k_scales": _w(torch.abs((lambda *s: torch.randn(*s, dtype=torch.bfloat16) * 1.6)(B, Hkv, ngk, Dh)) * 0.05 + 0.02),
        "k_zeros": _w((lambda *s: torch.randn(*s, dtype=torch.bfloat16) * 1.6)(B, Hkv, ngk, Dh) + float(qmax) / 2.0),
        "v_scales": _w(torch.abs((lambda *s: torch.randn(*s, dtype=torch.bfloat16) * 0.05)(B, Hkv, Skv, 1)) * 0.05 + 0.02),
        "v_zeros": _w((lambda *s: torch.randn(*s, dtype=torch.bfloat16) * 0.05)(B, Hkv, Skv, 1) + float(qmax) / 2.0),
    }

def reference(q, qk, qv, k_scales, k_zeros, v_scales, v_zeros):
    B, Hq, Sq, Dh = q.shape
    Hkv, Skv = qk.shape[1], qk.shape[2]
    ngk = k_scales.shape[2]
    G = Skv // ngk
    ks = (lambda x, n, axis: torch.repeat_interleave(x, n, dim=axis))(k_scales, G, axis=2)
    kz = (lambda x, n, axis: torch.repeat_interleave(x, n, dim=axis))(k_zeros, G, axis=2)
    k = ((lambda x, dt: x.to(dt))(qk, q.dtype) - kz) * ks
    v = ((lambda x, dt: x.to(dt))(qv, q.dtype) - v_zeros) * v_scales
    rep = Hq // Hkv
    if rep > 1:
        k = (lambda x, n, axis: torch.repeat_interleave(x, n, dim=axis))(k, rep, axis=1)
        v = (lambda x, n, axis: torch.repeat_interleave(x, n, dim=axis))(v, rep, axis=1)
    scale = float(Dh) ** -0.5
    logits = torch.einsum("bhqd,bhkd->bhqk", q, k) * scale
    p = _softmax(logits, axis=-1)
    o = torch.einsum("bhqk,bhkd->bhqd", p, v)
    return o
```

```asm
; @launch grid=(256,1,1) block=(256,1,1) lds=131072
.amdgcn_target "amdgcn-amd-amdhsa--gfx950"
.text
.globl standalone__kv_cache_quant_int4_int2_kv_with_per_channel_or_per_token_scales__prompt_kernel
.p2align 8
.type standalone__kv_cache_quant_int4_int2_kv_with_per_channel_or_per_token_scales__prompt_kernel,@function
standalone__kv_cache_quant_int4_int2_kv_with_per_channel_or_per_token_scales__prompt_kernel:
s_cmp_ge_u32 s2, 256
s_cbranch_scc1 Lat_done
s_mov_b32 s100, s2
s_load_dwordx16 s[36:51], s[0:1], 0
s_load_dwordx4 s[52:55], s[0:1], 64
s_memrealtime s[20:21]
v_lshrrev_b32 v7, 6, v0
v_and_b32 v0, 63, v0
v_readfirstlane_b32 s16, v7
s_and_b32 s30, s2, 7
s_lshr_b32 s31, s30, 1
s_and_b32 s26, s30, 1
s_lshr_b32 s27, s2, 3
s_lshl_b32 s30, s26, 5
s_add_u32 s30, s30, s27
s_mov_b32 s3, s30
s_sub_u32 s32, s16, 1
s_cmp_lt_u32 s16, 1
s_cselect_b32 s32, s16, s32
s_mul_i32 s22, s32, 5
s_mul_i32 s33, s30, 3
s_add_u32 s32, s32, s33
s_add_u32 s32, s32, 64
s_cmp_eq_u32 s16, 1
s_cselect_b32 s32, s30, s32
s_and_b32 s101, s32, 3
s_lshr_b32 s27, s32, 3
s_bfe_u32 s26, s32, 0x10002
s_lshl_b32 s32, s31, 6
s_add_u32 s30, s30, s32
s_lshl_b32 s30, s30, 16
s_lshl_b32 s17, s16, 12
s_add_u32 s23, s30, 16384
s_lshl_b32 s33, s16, 14
s_add_u32 s30, s30, s33
s_mov_b32 s24, s17
s_add_u32 s25, s17, 32768
v_lshlrev_b32 v1, 4, v0
v_add_u32 v2, 0x10000, v1
v_add_u32 v3, s17, v1
v_lshrrev_b32 v7, 4, v0
v_lshlrev_b32 v4, 4, v7
v_and_b32 v6, 15, v0
v_lshlrev_b32 v5, 4, v6
v_lshl_add_u32 v5, v7, 10, v5
v_lshlrev_b32 v6, 8, v6
v_lshl_add_u32 v6, v7, 4, v6
s_mov_b32 s18, 0
s_mov_b32 s19, 16384
s_mul_i32 s32, s31, 16384
s_add_u32 s32, s32, 4194304
s_and_b32 s34, s3, 15
s_lshl_b32 s34, s34, 10
s_add_u32 s34, s34, s32
v_lshlrev_b32 v236, 3, v0
v_add_u32 v236, s34, v236
s_lshl_b32 s33, s3, 3
s_add_u32 s33, s33, s32
v_lshlrev_b32 v237, 10, v0
v_add_u32 v237, s33, v237
s_lshl_b32 s28, s31, 5
s_add_u32 s28, s28, s27
s_lshl_b32 s28, s28, 15
s_lshl_b32 s29, s16, 12
s_add_u32 s29, s29, 114688
v_and_b32 v112, 31, v0
v_lshrrev_b32 v92, 5, v0
s_cmp_eq_u32 s26, 1
s_cbranch_scc1 Ldq_v
s_lshr_b32 s34, s101, 1
s_lshl_b32 s34, s34, 14
s_and_b32 s35, s101, 1
s_lshl_b32 s35, s35, 11
s_add_u32 s35, s35, s34
s_add_u32 s35, s35, s28
s_lshl_b32 s32, s31, 9
s_lshr_b32 s33, s27, 4
s_lshl_b32 s33, s33, 8
s_add_u32 s33, s33, s32
v_lshlrev_b32 v113, 3, v112
s_waitcnt lgkmcnt(0)
s_mov_b32 s56, s38
s_mov_b32 s57, s39
s_mov_b32 s58, 4194304
s_mov_b32 s59, 0x20000
buffer_load_dwordx4 v[28:31], v1, s[56:59], s35 offen offset:0
buffer_load_dwordx4 v[32:35], v1, s[56:59], s35 offen offset:1024
s_add_u32 s35, s35, 4096
buffer_load_dwordx4 v[36:39], v1, s[56:59], s35 offen offset:0
buffer_load_dwordx4 v[40:43], v1, s[56:59], s35 offen offset:1024
s_add_u32 s35, s35, 4096
buffer_load_dwordx4 v[44:47], v1, s[56:59], s35 offen offset:0
buffer_load_dwordx4 v[48:51], v1, s[56:59], s35 offen offset:1024
s_add_u32 s35, s35, 4096
buffer_load_dwordx4 v[52:55], v1, s[56:59], s35 offen offset:0
buffer_load_dwordx4 v[56:59], v1, s[56:59], s35 offen offset:1024
s_mov_b32 s60, s42
s_mov_b32 s61, s43
s_mov_b32 s62, 2048
s_mov_b32 s63, 0x20000
s_mov_b32 s64, s44
s_mov_b32 s65, s45
s_mov_b32 s66, 2048
s_mov_b32 s67, 0x20000
buffer_load_dwordx2 v[60:61], v113, s[60:63], s33 offen
buffer_load_dwordx2 v[62:63], v113, s[64:67], s33 offen
v_lshrrev_b32 v114, 3, v112
v_lshlrev_b32 v114, 10, v114
v_bfe_u32 v93, v0, 1, 2
v_lshl_add_u32 v114, v93, 8, v114
v_lshl_add_u32 v114, v92, 4, v114
v_and_b32 v93, 1, v0
v_lshl_add_u32 v114, v93, 3, v114
v_add_u32 v114, s29, v114
v_mov_b32 v115, v1
s_lshl_b32 s34, s101, 12
s_add_u32 s28, s28, s34
s_mov_b32 s38, 1024
s_branch Ldq_l2
Ldq_v:
s_lshl_b32 s35, s101, 13
s_add_u32 s35, s35, s28
v_lshlrev_b32 v113, 12, v92
v_lshl_add_u32 v113, v112, 4, v113
v_lshlrev_b32 v93, 4, v92
s_lshl_b32 s33, s31, 12
s_lshl_b32 s32, s27, 7
s_add_u32 s33, s33, s32
s_lshl_b32 s32, s101, 5
s_add_u32 s33, s33, s32
s_waitcnt lgkmcnt(0)
s_mov_b32 s56, s40
s_mov_b32 s57, s41
s_mov_b32 s58, 4194304
s_mov_b32 s59, 0x20000
buffer_load_dwordx4 v[28:31], v113, s[56:59], s35 offen offset:0
buffer_load_dwordx4 v[32:35], v113, s[56:59], s35 offen offset:512
buffer_load_dwordx4 v[36:39], v113, s[56:59], s35 offen offset:1024
buffer_load_dwordx4 v[40:43], v113, s[56:59], s35 offen offset:1536
buffer_load_dwordx4 v[44:47], v113, s[56:59], s35 offen offset:2048
buffer_load_dwordx4 v[48:51], v113, s[56:59], s35 offen offset:2560
buffer_load_dwordx4 v[52:55], v113, s[56:59], s35 offen offset:3072
buffer_load_dwordx4 v[56:59], v113, s[56:59], s35 offen offset:3584
s_mov_b32 s60, s46
s_mov_b32 s61, s47
s_mov_b32 s62, 16384
s_mov_b32 s63, 0x20000
s_mov_b32 s64, s48
s_mov_b32 s65, s49
s_mov_b32 s66, 16384
s_mov_b32 s67, 0x20000
buffer_load_dwordx4 v[60:63], v93, s[60:63], s33 offen
buffer_load_dwordx4 v[64:67], v93, s[64:67], s33 offen
v_and_b32 v114, 1, v0
v_lshlrev_b32 v114, 11, v114
v_lshl_add_u32 v114, v92, 8, v114
v_lshrrev_b32 v94, 1, v112
v_lshl_add_u32 v114, v94, 4, v114
v_add_u32 v114, s29, v114
v_lshlrev_b32 v115, 10, v92
v_lshl_add_u32 v115, v112, 4, v115
s_lshr_b32 s34, s101, 1
s_lshl_b32 s34, s34, 13
s_and_b32 s32, s101, 1
s_lshl_b32 s32, s32, 9
s_add_u32 s34, s34, s32
s_add_u32 s34, s34, 16384
s_add_u32 s28, s28, s34
s_mov_b32 s38, 2048
Ldq_l2:
s_lshl_b32 s32, s31, 20
s_mov_b32 s4, s36
s_mov_b32 s5, s37
s_mov_b32 s6, 16777216
s_mov_b32 s7, 0x20000
s_add_u32 s8, s54, s32
s_addc_u32 s9, s55, 0
s_mov_b32 s10, 0x100000
s_mov_b32 s11, 0x20000
s_mov_b32 s12, s50
s_mov_b32 s13, s51
s_mov_b32 s14, 16777216
s_mov_b32 s15, 0x20000
s_mov_b32 s68, s54
s_mov_b32 s69, s55
s_mov_b32 s70, 4259840
s_mov_b32 s71, 0x20000
s_mov_b32 s72, s52
s_mov_b32 s73, s53
s_mov_b32 s74, 256
s_mov_b32 s75, 0x20000
s_cmp_lg_u32 s16, 1
s_cbranch_scc1 Ltok_skip
s_or_b32 s20, s20, 1
v_mov_b32 v8, s20
v_mov_b32 v9, s21
v_mov_b32 v10, 0
v_mov_b32 v11, 0
s_lshl_b32 s32, s31, 6
v_mov_b32 v12, s32
s_mov_b64 exec, 1
buffer_atomic_cmpswap_x2 v[8:11], v12, s[72:75], 0 offen sc0
s_mov_b64 exec, -1
Ltok_skip:
v_mov_b32 v16, 0
v_mov_b32 v17, 0
v_mov_b32 v18, 0
v_mov_b32 v19, 0
v_accvgpr_write_b32 a0, 0
v_accvgpr_write_b32 a1, 0
v_accvgpr_write_b32 a2, 0
v_accvgpr_write_b32 a3, 0
v_accvgpr_write_b32 a4, 0
v_accvgpr_write_b32 a5, 0
v_accvgpr_write_b32 a6, 0
v_accvgpr_write_b32 a7, 0
v_accvgpr_write_b32 a8, 0
v_accvgpr_write_b32 a9, 0
v_accvgpr_write_b32 a10, 0
v_accvgpr_write_b32 a11, 0
v_accvgpr_write_b32 a12, 0
v_accvgpr_write_b32 a13, 0
v_accvgpr_write_b32 a14, 0
v_accvgpr_write_b32 a15, 0
v_accvgpr_write_b32 a16, 0
v_accvgpr_write_b32 a17, 0
v_accvgpr_write_b32 a18, 0
v_accvgpr_write_b32 a19, 0
v_accvgpr_write_b32 a20, 0
v_accvgpr_write_b32 a21, 0
v_accvgpr_write_b32 a22, 0
v_accvgpr_write_b32 a23, 0
v_accvgpr_write_b32 a24, 0
v_accvgpr_write_b32 a25, 0
v_accvgpr_write_b32 a26, 0
v_accvgpr_write_b32 a27, 0
v_accvgpr_write_b32 a28, 0
v_accvgpr_write_b32 a29, 0
v_accvgpr_write_b32 a30, 0
v_accvgpr_write_b32 a31, 0
v_accvgpr_write_b32 a32, 0
v_accvgpr_write_b32 a33, 0
v_accvgpr_write_b32 a34, 0
v_accvgpr_write_b32 a35, 0
v_accvgpr_write_b32 a36, 0
v_accvgpr_write_b32 a37, 0
v_accvgpr_write_b32 a38, 0
v_accvgpr_write_b32 a39, 0
v_accvgpr_write_b32 a40, 0
v_accvgpr_write_b32 a41, 0
v_accvgpr_write_b32 a42, 0
v_accvgpr_write_b32 a43, 0
v_accvgpr_write_b32 a44, 0
v_accvgpr_write_b32 a45, 0
v_accvgpr_write_b32 a46, 0
v_accvgpr_write_b32 a47, 0
v_accvgpr_write_b32 a48, 0
v_accvgpr_write_b32 a49, 0
v_accvgpr_write_b32 a50, 0
v_accvgpr_write_b32 a51, 0
v_accvgpr_write_b32 a52, 0
v_accvgpr_write_b32 a53, 0
v_accvgpr_write_b32 a54, 0
v_accvgpr_write_b32 a55, 0
v_accvgpr_write_b32 a56, 0
v_accvgpr_write_b32 a57, 0
v_accvgpr_write_b32 a58, 0
v_accvgpr_write_b32 a59, 0
v_accvgpr_write_b32 a60, 0
v_accvgpr_write_b32 a61, 0
v_accvgpr_write_b32 a62, 0
v_accvgpr_write_b32 a63, 0
v_accvgpr_write_b32 a64, 0
v_accvgpr_write_b32 a65, 0
v_accvgpr_write_b32 a66, 0
v_accvgpr_write_b32 a67, 0
v_accvgpr_write_b32 a68, 0
v_accvgpr_write_b32 a69, 0
v_accvgpr_write_b32 a70, 0
v_accvgpr_write_b32 a71, 0
v_accvgpr_write_b32 a72, 0
v_accvgpr_write_b32 a73, 0
v_accvgpr_write_b32 a74, 0
v_accvgpr_write_b32 a75, 0
v_accvgpr_write_b32 a76, 0
v_accvgpr_write_b32 a77, 0
v_accvgpr_write_b32 a78, 0
v_accvgpr_write_b32 a79, 0
v_accvgpr_write_b32 a80, 0
v_accvgpr_write_b32 a81, 0
v_accvgpr_write_b32 a82, 0
v_accvgpr_write_b32 a83, 0
v_accvgpr_write_b32 a84, 0
v_accvgpr_write_b32 a85, 0
v_accvgpr_write_b32 a86, 0
v_accvgpr_write_b32 a87, 0
v_accvgpr_write_b32 a88, 0
v_accvgpr_write_b32 a89, 0
v_accvgpr_write_b32 a90, 0
v_accvgpr_write_b32 a91, 0
v_accvgpr_write_b32 a92, 0
v_accvgpr_write_b32 a93, 0
v_accvgpr_write_b32 a94, 0
v_accvgpr_write_b32 a95, 0
v_accvgpr_write_b32 a96, 0
v_accvgpr_write_b32 a97, 0
v_accvgpr_write_b32 a98, 0
v_accvgpr_write_b32 a99, 0
v_accvgpr_write_b32 a100, 0
v_accvgpr_write_b32 a101, 0
v_accvgpr_write_b32 a102, 0
v_accvgpr_write_b32 a103, 0
v_accvgpr_write_b32 a104, 0
v_accvgpr_write_b32 a105, 0
v_accvgpr_write_b32 a106, 0
v_accvgpr_write_b32 a107, 0
v_accvgpr_write_b32 a108, 0
v_accvgpr_write_b32 a109, 0
v_accvgpr_write_b32 a110, 0
v_accvgpr_write_b32 a111, 0
v_accvgpr_write_b32 a112, 0
v_accvgpr_write_b32 a113, 0
v_accvgpr_write_b32 a114, 0
v_accvgpr_write_b32 a115, 0
v_accvgpr_write_b32 a116, 0
v_accvgpr_write_b32 a117, 0
v_accvgpr_write_b32 a118, 0
v_accvgpr_write_b32 a119, 0
v_accvgpr_write_b32 a120, 0
v_accvgpr_write_b32 a121, 0
v_accvgpr_write_b32 a122, 0
v_accvgpr_write_b32 a123, 0
v_accvgpr_write_b32 a124, 0
v_accvgpr_write_b32 a125, 0
v_accvgpr_write_b32 a126, 0
v_accvgpr_write_b32 a127, 0
s_mov_b32 s36, 0x3e0293ee
s_mov_b32 s37, 0x3e0293ee
s_cmp_eq_u32 s16, 1
s_cbranch_scc1 Lqa_skip
s_add_u32 s33, s30, 0
buffer_load_dwordx4 a[128:131], v6, s[4:7], s33 offen offset:0
buffer_load_dwordx4 a[132:135], v6, s[4:7], s33 offen offset:64
buffer_load_dwordx4 a[136:139], v6, s[4:7], s33 offen offset:128
buffer_load_dwordx4 a[140:143], v6, s[4:7], s33 offen offset:192
s_waitcnt vmcnt(4)
s_add_u32 s33, s30, 4096
buffer_load_dwordx4 a[144:147], v6, s[4:7], s33 offen offset:0
buffer_load_dwordx4 a[148:151], v6, s[4:7], s33 offen offset:64
buffer_load_dwordx4 a[152:155], v6, s[4:7], s33 offen offset:128
buffer_load_dwordx4 a[156:159], v6, s[4:7], s33 offen offset:192
s_add_u32 s33, s30, 8192
buffer_load_dwordx4 a[160:163], v6, s[4:7], s33 offen offset:0
buffer_load_dwordx4 a[164:167], v6, s[4:7], s33 offen offset:64
buffer_load_dwordx4 a[168:171], v6, s[4:7], s33 offen offset:128
buffer_load_dwordx4 a[172:175], v6, s[4:7], s33 offen offset:192
s_add_u32 s33, s30, 12288
buffer_load_dwordx4 a[176:179], v6, s[4:7], s33 offen offset:0
buffer_load_dwordx4 a[180:183], v6, s[4:7], s33 offen offset:64
buffer_load_dwordx4 a[184:187], v6, s[4:7], s33 offen offset:128
buffer_load_dwordx4 a[188:191], v6, s[4:7], s33 offen offset:192
s_branch Lqa_j
Lqa_skip:
s_waitcnt vmcnt(1)
Lqa_j:
s_cmp_eq_u32 s26, 1
s_cbranch_scc1 Ldq_v2
v_lshlrev_b32 v68, 16, v60
v_and_b32 v69, 0xffff0000, v60
v_lshlrev_b32 v70, 16, v61
v_and_b32 v71, 0xffff0000, v61
v_lshlrev_b32 v72, 16, v62
v_and_b32 v73, 0xffff0000, v62
v_lshlrev_b32 v74, 16, v63
v_and_b32 v75, 0xffff0000, v63
s_mov_b32 s34, 0
Lkrt_loop:
s_set_gpr_idx_on s34, 0x1
v_cvt_f32_i32 v84, v28
v_cvt_f32_i32 v85, v29
v_cvt_f32_i32 v86, v30
v_cvt_f32_i32 v87, v31
v_cvt_f32_i32 v88, v32
v_cvt_f32_i32 v89, v33
v_cvt_f32_i32 v90, v34
v_cvt_f32_i32 v91, v35
s_set_gpr_idx_off
v_cvt_pk_bf16_f32 v92, v84, v85
v_cvt_pk_bf16_f32 v93, v86, v87
v_cvt_pk_bf16_f32 v94, v88, v89
v_cvt_pk_bf16_f32 v95, v90, v91
v_lshlrev_b32 v84, 16, v92
v_and_b32 v85, 0xffff0000, v92
v_lshlrev_b32 v86, 16, v93
v_and_b32 v87, 0xffff0000, v93
v_lshlrev_b32 v88, 16, v94
v_and_b32 v89, 0xffff0000, v94
v_lshlrev_b32 v90, 16, v95
v_and_b32 v91, 0xffff0000, v95
v_pk_add_f32 v[84:85], v[84:85], v[72:73] neg_lo:[0,1] neg_hi:[0,1]
v_pk_add_f32 v[86:87], v[86:87], v[74:75] neg_lo:[0,1] neg_hi:[0,1]
v_pk_add_f32 v[88:89], v[88:89], v[72:73] neg_lo:[0,1] neg_hi:[0,1]
v_pk_add_f32 v[90:91], v[90:91], v[74:75] neg_lo:[0,1] neg_hi:[0,1]
v_cvt_pk_bf16_f32 v92, v84, v85
v_cvt_pk_bf16_f32 v93, v86, v87
v_cvt_pk_bf16_f32 v94, v88, v89
v_cvt_pk_bf16_f32 v95, v90, v91
v_lshlrev_b32 v84, 16, v92
v_and_b32 v85, 0xffff0000, v92
v_lshlrev_b32 v86, 16, v93
v_and_b32 v87, 0xffff0000, v93
v_lshlrev_b32 v88, 16, v94
v_and_b32 v89, 0xffff0000, v94
v_lshlrev_b32 v90, 16, v95
v_and_b32 v91, 0xffff0000, v95
v_pk_mul_f32 v[84:85], v[84:85], v[68:69]
v_pk_mul_f32 v[86:87], v[86:87], v[70:71]
v_pk_mul_f32 v[88:89], v[88:89], v[68:69]
v_pk_mul_f32 v[90:91], v[90:91], v[70:71]
v_cvt_pk_bf16_f32 v92, v84, v85
v_cvt_pk_bf16_f32 v93, v86, v87
v_cvt_pk_bf16_f32 v94, v88, v89
v_cvt_pk_bf16_f32 v95, v90, v91
v_lshlrev_b32 v84, 16, v92
v_and_b32 v85, 0xffff0000, v92
v_lshlrev_b32 v86, 16, v93
v_and_b32 v87, 0xffff0000, v93
v_lshlrev_b32 v88, 16, v94
v_and_b32 v89, 0xffff0000, v94
v_lshlrev_b32 v90, 16, v95
v_and_b32 v91, 0xffff0000, v95
v_pk_mul_f32 v[84:85], v[84:85], s[36:37]
v_pk_mul_f32 v[86:87], v[86:87], s[36:37]
v_pk_mul_f32 v[88:89], v[88:89], s[36:37]
v_pk_mul_f32 v[90:91], v[90:91], s[36:37]
v_cvt_pk_bf16_f32 v96, v84, v85
v_cvt_pk_bf16_f32 v97, v86, v87
v_cvt_pk_bf16_f32 v98, v88, v89
v_cvt_pk_bf16_f32 v99, v90, v91
ds_write_b64 v114, v[96:97]
ds_write_b64 v114, v[98:99] offset:32
v_add_u32 v114, 64, v114
s_add_u32 s34, s34, 8
s_cmp_lg_u32 s34, 32
s_cbranch_scc1 Lkrt_loop
s_branch Ldq_join
Ldq_v2:
v_lshlrev_b32 v68, 16, v60
v_and_b32 v69, 0xffff0000, v60
v_lshlrev_b32 v70, 16, v61
v_and_b32 v71, 0xffff0000, v61
v_lshlrev_b32 v72, 16, v62
v_and_b32 v73, 0xffff0000, v62
v_lshlrev_b32 v74, 16, v63
v_and_b32 v75, 0xffff0000, v63
v_lshlrev_b32 v76, 16, v64
v_and_b32 v77, 0xffff0000, v64
v_lshlrev_b32 v78, 16, v65
v_and_b32 v79, 0xffff0000, v65
v_lshlrev_b32 v80, 16, v66
v_and_b32 v81, 0xffff0000, v66
v_lshlrev_b32 v82, 16, v67
v_and_b32 v83, 0xffff0000, v67
v_cvt_f32_i32 v28, v28
v_cvt_f32_i32 v29, v29
v_cvt_f32_i32 v30, v30
v_cvt_f32_i32 v31, v31
v_cvt_f32_i32 v32, v32
v_cvt_f32_i32 v33, v33
v_cvt_f32_i32 v34, v34
v_cvt_f32_i32 v35, v35
v_cvt_pk_bf16_f32 v92, v28, v29
v_cvt_pk_bf16_f32 v93, v30, v31
v_cvt_pk_bf16_f32 v94, v32, v33
v_cvt_pk_bf16_f32 v95, v34, v35
v_lshlrev_b32 v28, 16, v92
v_and_b32 v29, 0xffff0000, v92
v_lshlrev_b32 v30, 16, v93
v_and_b32 v31, 0xffff0000, v93
v_lshlrev_b32 v32, 16, v94
v_and_b32 v33, 0xffff0000, v94
v_lshlrev_b32 v34, 16, v95
v_and_b32 v35, 0xffff0000, v95
v_pk_add_f32 v[28:29], v[28:29], v[76:77] op_sel:[0,0] op_sel_hi:[1,0] neg_lo:[0,1] neg_hi:[0,1]
v_pk_add_f32 v[30:31], v[30:31], v[76:77] op_sel:[0,0] op_sel_hi:[1,0] neg_lo:[0,1] neg_hi:[0,1]
v_pk_add_f32 v[32:33], v[32:33], v[76:77] op_sel:[0,1] op_sel_hi:[1,1] neg_lo:[0,1] neg_hi:[0,1]
v_pk_add_f32 v[34:35], v[34:35], v[76:77] op_sel:[0,1] op_sel_hi:[1,1] neg_lo:[0,1] neg_hi:[0,1]
v_cvt_pk_bf16_f32 v92, v28, v29
v_cvt_pk_bf16_f32 v93, v30, v31
v_cvt_pk_bf16_f32 v94, v32, v33
v_cvt_pk_bf16_f32 v95, v34, v35
v_lshlrev_b32 v28, 16, v92
v_and_b32 v29, 0xffff0000, v92
v_lshlrev_b32 v30, 16, v93
v_and_b32 v31, 0xffff0000, v93
v_lshlrev_b32 v32, 16, v94
v_and_b32 v33, 0xffff0000, v94
v_lshlrev_b32 v34, 16, v95
v_and_b32 v35, 0xffff0000, v95
v_pk_mul_f32 v[28:29], v[28:29], v[68:69] op_sel:[0,0] op_sel_hi:[1,0]
v_pk_mul_f32 v[30:31], v[30:31], v[68:69] op_sel:[0,0] op_sel_hi:[1,0]
v_pk_mul_f32 v[32:33], v[32:33], v[68:69] op_sel:[0,1] op_sel_hi:[1,1]
v_pk_mul_f32 v[34:35], v[34:35], v[68:69] op_sel:[0,1] op_sel_hi:[1,1]
v_cvt_pk_bf16_f32 v96, v28, v32
v_cvt_pk_bf16_f32 v100, v29, v33
v_cvt_pk_bf16_f32 v104, v30, v34
v_cvt_pk_bf16_f32 v108, v31, v35
v_cvt_f32_i32 v36, v36
v_cvt_f32_i32 v37, v37
v_cvt_f32_i32 v38, v38
v_cvt_f32_i32 v39, v39
v_cvt_f32_i32 v40, v40
v_cvt_f32_i32 v41, v41
v_cvt_f32_i32 v42, v42
v_cvt_f32_i32 v43, v43
v_cvt_pk_bf16_f32 v92, v36, v37
v_cvt_pk_bf16_f32 v93, v38, v39
v_cvt_pk_bf16_f32 v94, v40, v41
v_cvt_pk_bf16_f32 v95, v42, v43
v_lshlrev_b32 v36, 16, v92
v_and_b32 v37, 0xffff0000, v92
v_lshlrev_b32 v38, 16, v93
v_and_b32 v39, 0xffff0000, v93
v_lshlrev_b32 v40, 16, v94
v_and_b32 v41, 0xffff0000, v94
v_lshlrev_b32 v42, 16, v95
v_and_b32 v43, 0xffff0000, v95
v_pk_add_f32 v[36:37], v[36:37], v[78:79] op_sel:[0,0] op_sel_hi:[1,0] neg_lo:[0,1] neg_hi:[0,1]
v_pk_add_f32 v[38:39], v[38:39], v[78:79] op_sel:[0,0] op_sel_hi:[1,0] neg_lo:[0,1] neg_hi:[0,1]
v_pk_add_f32 v[40:41], v[40:41], v[78:79] op_sel:[0,1] op_sel_hi:[1,1] neg_lo:[0,1] neg_hi:[0,1]
v_pk_add_f32 v[42:43], v[42:43], v[78:79] op_sel:[0,1] op_sel_hi:[1,1] neg_lo:[0,1] neg_hi:[0,1]
v_cvt_pk_bf16_f32 v92, v36, v37
v_cvt_pk_bf16_f32 v93, v38, v39
v_cvt_pk_bf16_f32 v94, v40, v41
v_cvt_pk_bf16_f32 v95, v42, v43
v_lshlrev_b32 v36, 16, v92
v_and_b32 v37, 0xffff0000, v92
v_lshlrev_b32 v38, 16, v93
v_and_b32 v39, 0xffff0000, v93
v_lshlrev_b32 v40, 16, v94
v_and_b32 v41, 0xffff0000, v94
v_lshlrev_b32 v42, 16, v95
v_and_b32 v43, 0xffff0000, v95
v_pk_mul_f32 v[36:37], v[36:37], v[70:71] op_sel:[0,0] op_sel_hi:[1,0]
v_pk_mul_f32 v[38:39], v[38:39], v[70:71] op_sel:[0,0] op_sel_hi:[1,0]
v_pk_mul_f32 v[40:41], v[40:41], v[70:71] op_sel:[0,1] op_sel_hi:[1,1]
v_pk_mul_f32 v[42:43], v[42:43], v[70:71] op_sel:[0,1] op_sel_hi:[1,1]
v_cvt_pk_bf16_f32 v97, v36, v40
v_cvt_pk_bf16_f32 v101, v37, v41
v_cvt_pk_bf16_f32 v105, v38, v42
v_cvt_pk_bf16_f32 v109, v39, v43
v_cvt_f32_i32 v44, v44
v_cvt_f32_i32 v45, v45
v_cvt_f32_i32 v46, v46
v_cvt_f32_i32 v47, v47
v_cvt_f32_i32 v48, v48
v_cvt_f32_i32 v49, v49
v_cvt_f32_i32 v50, v50
v_cvt_f32_i32 v51, v51
v_cvt_pk_bf16_f32 v92, v44, v45
v_cvt_pk_bf16_f32 v93, v46, v47
v_cvt_pk_bf16_f32 v94, v48, v49
v_cvt_pk_bf16_f32 v95, v50, v51
v_lshlrev_b32 v44, 16, v92
v_and_b32 v45, 0xffff0000, v92
v_lshlrev_b32 v46, 16, v93
v_and_b32 v47, 0xffff0000, v93
v_lshlrev_b32 v48, 16, v94
v_and_b32 v49, 0xffff0000, v94
v_lshlrev_b32 v50, 16, v95
v_and_b32 v51, 0xffff0000, v95
v_pk_add_f32 v[44:45], v[44:45], v[80:81] op_sel:[0,0] op_sel_hi:[1,0] neg_lo:[0,1] neg_hi:[0,1]
v_pk_add_f32 v[46:47], v[46:47], v[80:81] op_sel:[0,0] op_sel_hi:[1,0] neg_lo:[0,1] neg_hi:[0,1]
v_pk_add_f32 v[48:49], v[48:49], v[80:81] op_sel:[0,1] op_sel_hi:[1,1] neg_lo:[0,1] neg_hi:[0,1]
v_pk_add_f32 v[50:51], v[50:51], v[80:81] op_sel:[0,1] op_sel_hi:[1,1] neg_lo:[0,1] neg_hi:[0,1]
v_cvt_pk_bf16_f32 v92, v44, v45
v_cvt_pk_bf16_f32 v93, v46, v47
v_cvt_pk_bf16_f32 v94, v48, v49
v_cvt_pk_bf16_f32 v95, v50, v51
v_lshlrev_b32 v44, 16, v92
v_and_b32 v45, 0xffff0000, v92
v_lshlrev_b32 v46, 16, v93
v_and_b32 v47, 0xffff0000, v93
v_lshlrev_b32 v48, 16, v94
v_and_b32 v49, 0xffff0000, v94
v_lshlrev_b32 v50, 16, v95
v_and_b32 v51, 0xffff0000, v95
v_pk_mul_f32 v[44:45], v[44:45], v[72:73] op_sel:[0,0] op_sel_hi:[1,0]
v_pk_mul_f32 v[46:47], v[46:47], v[72:73] op_sel:[0,0] op_sel_hi:[1,0]
v_pk_mul_f32 v[48:49], v[48:49], v[72:73] op_sel:[0,1] op_sel_hi:[1,1]
v_pk_mul_f32 v[50:51], v[50:51], v[72:73] op_sel:[0,1] op_sel_hi:[1,1]
v_cvt_pk_bf16_f32 v98, v44, v48
v_cvt_pk_bf16_f32 v102, v45, v49
v_cvt_pk_bf16_f32 v106, v46, v50
v_cvt_pk_bf16_f32 v110, v47, v51
v_cvt_f32_i32 v52, v52
v_cvt_f32_i32 v53, v53
v_cvt_f32_i32 v54, v54
v_cvt_f32_i32 v55, v55
v_cvt_f32_i32 v56, v56
v_cvt_f32_i32 v57, v57
v_cvt_f32_i32 v58, v58
v_cvt_f32_i32 v59, v59
v_cvt_pk_bf16_f32 v92, v52, v53
v_cvt_pk_bf16_f32 v93, v54, v55
v_cvt_pk_bf16_f32 v94, v56, v57
v_cvt_pk_bf16_f32 v95, v58, v59
v_lshlrev_b32 v52, 16, v92
v_and_b32 v53, 0xffff0000, v92
v_lshlrev_b32 v54, 16, v93
v_and_b32 v55, 0xffff0000, v93
v_lshlrev_b32 v56, 16, v94
v_and_b32 v57, 0xffff0000, v94
v_lshlrev_b32 v58, 16, v95
v_and_b32 v59, 0xffff0000, v95
v_pk_add_f32 v[52:53], v[52:53], v[82:83] op_sel:[0,0] op_sel_hi:[1,0] neg_lo:[0,1] neg_hi:[0,1]
v_pk_add_f32 v[54:55], v[54:55], v[82:83] op_sel:[0,0] op_sel_hi:[1,0] neg_lo:[0,1] neg_hi:[0,1]
v_pk_add_f32 v[56:57], v[56:57], v[82:83] op_sel:[0,1] op_sel_hi:[1,1] neg_lo:[0,1] neg_hi:[0,1]
v_pk_add_f32 v[58:59], v[58:59], v[82:83] op_sel:[0,1] op_sel_hi:[1,1] neg_lo:[0,1] neg_hi:[0,1]
v_cvt_pk_bf16_f32 v92, v52, v53
v_cvt_pk_bf16_f32 v93, v54, v55
v_cvt_pk_bf16_f32 v94, v56, v57
v_cvt_pk_bf16_f32 v95, v58, v59
v_lshlrev_b32 v52, 16, v92
v_and_b32 v53, 0xffff0000, v92
v_lshlrev_b32 v54, 16, v93
v_and_b32 v55, 0xffff0000, v93
v_lshlrev_b32 v56, 16, v94
v_and_b32 v57, 0xffff0000, v94
v_lshlrev_b32 v58, 16, v95
v_and_b32 v59, 0xffff0000, v95
v_pk_mul_f32 v[52:53], v[52:53], v[74:75] op_sel:[0,0] op_sel_hi:[1,0]
v_pk_mul_f32 v[54:55], v[54:55], v[74:75] op_sel:[0,0] op_sel_hi:[1,0]
v_pk_mul_f32 v[56:57], v[56:57], v[74:75] op_sel:[0,1] op_sel_hi:[1,1]
v_pk_mul_f32 v[58:59], v[58:59], v[74:75] op_sel:[0,1] op_sel_hi:[1,1]
v_cvt_pk_bf16_f32 v99, v52, v56
v_cvt_pk_bf16_f32 v103, v53, v57
v_cvt_pk_bf16_f32 v107, v54, v58
v_cvt_pk_bf16_f32 v111, v55, v59
ds_write_b128 v114, v[96:99] offset:0
ds_write_b128 v114, v[100:103] offset:512
ds_write_b128 v114, v[104:107] offset:1024
ds_write_b128 v114, v[108:111] offset:1536
Ldq_join:
v_add_u32 v12, s29, v1
s_waitcnt lgkmcnt(0)
ds_read_b128 a[192:195], v12 offset:0
ds_read_b128 a[196:199], v12 offset:1024
ds_read_b128 a[200:203], v12 offset:2048
ds_read_b128 a[204:207], v12 offset:3072
s_waitcnt lgkmcnt(3)
buffer_store_dwordx4 a[192:195], v115, s[68:71], s28 offen sc1
s_add_u32 s28, s28, s38
s_waitcnt lgkmcnt(2)
buffer_store_dwordx4 a[196:199], v115, s[68:71], s28 offen sc1
s_add_u32 s28, s28, s38
s_waitcnt lgkmcnt(1)
buffer_store_dwordx4 a[200:203], v115, s[68:71], s28 offen sc1
s_add_u32 s28, s28, s38
s_waitcnt lgkmcnt(0)
buffer_store_dwordx4 a[204:207], v115, s[68:71], s28 offen sc1
s_cmp_lg_u32 s16, 1
s_cbranch_scc1 LpollA_np
s_waitcnt vmcnt(0)
v_readfirstlane_b32 s32, v8
v_readfirstlane_b32 s33, v9
s_or_b32 s34, s32, s33
s_cselect_b32 s20, s32, s20
s_cselect_b32 s21, s33, s21
v_mov_b32 v238, s20
v_mov_b32 v239, s21
s_mov_b64 exec, 65535
buffer_store_dwordx2 v[238:239], v237, s[68:71], 0 offen offset:0 sc1
s_mov_b64 exec, -1
s_mov_b32 s33, 131072
LpollA:
buffer_load_dwordx2 v[240:241], v236, s[68:71], 0 offen offset:0 sc1
s_sub_u32 s33, s33, 1
s_cmp_eq_u32 s33, 0
s_cbranch_scc1 LpollA_ok
s_waitcnt vmcnt(0)
v_cmp_ne_u64 vcc, v[240:241], v[238:239]
s_cbranch_vccnz LpollA
s_branch LpollA_ok
LpollA_np:
s_add_u32 s32, s22, 0
s_min_u32 s32, s32, 15
s_lshr_b32 s33, s32, 2
s_lshl_b32 s33, s33, 12
s_and_b32 s34, s32, 3
s_lshl_b32 s34, s34, 6
s_add_u32 s33, s33, s34
s_lshl_b32 s32, s32, 10
s_add_u32 m0, s32, 98304
s_add_u32 s33, s33, s23
buffer_load_dwordx4 v6, s[4:7], s33 offen lds
s_add_u32 s32, s22, 1
s_min_u32 s32, s32, 15
s_lshr_b32 s33, s32, 2
s_lshl_b32 s33, s33, 12
s_and_b32 s34, s32, 3
s_lshl_b32 s34, s34, 6
s_add_u32 s33, s33, s34
s_lshl_b32 s32, s32, 10
s_add_u32 m0, s32, 98304
s_add_u32 s33, s33, s23
buffer_load_dwordx4 v6, s[4:7], s33 offen lds
s_add_u32 s32, s22, 2
s_min_u32 s32, s32, 15
s_lshr_b32 s33, s32, 2
s_lshl_b32 s33, s33, 12
s_and_b32 s34, s32, 3
s_lshl_b32 s34, s34, 6
s_add_u32 s33, s33, s34
s_lshl_b32 s32, s32, 10
s_add_u32 m0, s32, 98304
s_add_u32 s33, s33, s23
buffer_load_dwordx4 v6, s[4:7], s33 offen lds
s_add_u32 s32, s22, 3
s_min_u32 s32, s32, 15
s_lshr_b32 s33, s32, 2
s_lshl_b32 s33, s33, 12
s_and_b32 s34, s32, 3
s_lshl_b32 s34, s34, 6
s_add_u32 s33, s33, s34
s_lshl_b32 s32, s32, 10
s_add_u32 m0, s32, 98304
s_add_u32 s33, s33, s23
buffer_load_dwordx4 v6, s[4:7], s33 offen lds
s_add_u32 s32, s22, 4
s_min_u32 s32, s32, 15
s_lshr_b32 s33, s32, 2
s_lshl_b32 s33, s33, 12
s_and_b32 s34, s32, 3
s_lshl_b32 s34, s34, 6
s_add_u32 s33, s33, s34
s_lshl_b32 s32, s32, 10
s_add_u32 m0, s32, 98304
s_add_u32 s33, s33, s23
buffer_load_dwordx4 v6, s[4:7], s33 offen lds
s_add_u32 s32, s22, 5
s_min_u32 s32, s32, 15
s_lshr_b32 s33, s32, 2
s_lshl_b32 s33, s33, 12
s_and_b32 s34, s32, 3
s_lshl_b32 s34, s34, 6
s_add_u32 s33, s33, s34
s_lshl_b32 s32, s32, 10
s_add_u32 m0, s32, 98304
s_add_u32 s33, s33, s23
buffer_load_dwordx4 v6, s[4:7], s33 offen lds
s_waitcnt vmcnt(0)
LpollA_ok:
s_mov_b32 s21, 0x47800000
s_barrier
s_add_u32 m0, s24, 0
s_nop 0
buffer_load_dwordx4 v3, s[8:11], s18 offen offset:0 sc1 lds
buffer_load_dwordx4 v3, s[8:11], s18 offen offset:1024 sc1 lds
buffer_load_dwordx4 v3, s[8:11], s18 offen offset:2048 sc1 lds
buffer_load_dwordx4 v3, s[8:11], s18 offen offset:3072 sc1 lds
s_add_u32 s18, s18, 32768
s_cmp_lg_u32 s16, 1
s_cbranch_scc1 Llq_skip
v_add_u32 v8, 98304, v1
ds_read_b128 a[128:131], v8 offset:0
ds_read_b128 a[132:135], v8 offset:1024
ds_read_b128 a[136:139], v8 offset:2048
ds_read_b128 a[140:143], v8 offset:3072
ds_read_b128 a[144:147], v8 offset:4096
ds_read_b128 a[148:151], v8 offset:5120
ds_read_b128 a[152:155], v8 offset:6144
ds_read_b128 a[156:159], v8 offset:7168
ds_read_b128 a[160:163], v8 offset:8192
ds_read_b128 a[164:167], v8 offset:9216
ds_read_b128 a[168:171], v8 offset:10240
ds_read_b128 a[172:175], v8 offset:11264
ds_read_b128 a[176:179], v8 offset:12288
ds_read_b128 a[180:183], v8 offset:13312
ds_read_b128 a[184:187], v8 offset:14336
ds_read_b128 a[188:191], v8 offset:15360
Llq_skip:
s_add_u32 m0, s24, 16384
s_nop 0
buffer_load_dwordx4 v3, s[8:11], s18 offen offset:0 sc1 lds
buffer_load_dwordx4 v3, s[8:11], s18 offen offset:1024 sc1 lds
buffer_load_dwordx4 v3, s[8:11], s18 offen offset:2048 sc1 lds
buffer_load_dwordx4 v3, s[8:11], s18 offen offset:3072 sc1 lds
s_add_u32 s18, s18, 32768
s_add_u32 m0, s24, 65536
s_nop 0
buffer_load_dwordx4 v3, s[8:11], s19 offen offset:0 sc1 lds
buffer_load_dwordx4 v3, s[8:11], s19 offen offset:1024 sc1 lds
buffer_load_dwordx4 v3, s[8:11], s19 offen offset:2048 sc1 lds
buffer_load_dwordx4 v3, s[8:11], s19 offen offset:3072 sc1 lds
s_add_u32 s19, s19, 32768
s_add_u32 m0, s25, 0
s_nop 0
buffer_load_dwordx4 v3, s[8:11], s18 offen offset:0 sc1 lds
buffer_load_dwordx4 v3, s[8:11], s18 offen offset:1024 sc1 lds
buffer_load_dwordx4 v3, s[8:11], s18 offen offset:2048 sc1 lds
buffer_load_dwordx4 v3, s[8:11], s18 offen offset:3072 sc1 lds
s_add_u32 s18, s18, 32768
s_add_u32 m0, s24, 81920
s_nop 0
buffer_load_dwordx4 v3, s[8:11], s19 offen offset:0 sc1 lds
buffer_load_dwordx4 v3, s[8:11], s19 offen offset:1024 sc1 lds
buffer_load_dwordx4 v3, s[8:11], s19 offen offset:2048 sc1 lds
buffer_load_dwordx4 v3, s[8:11], s19 offen offset:3072 sc1 lds
s_add_u32 s19, s19, 32768
s_add_u32 m0, s25, 16384
s_nop 0
buffer_load_dwordx4 v3, s[8:11], s18 offen offset:0 sc1 lds
buffer_load_dwordx4 v3, s[8:11], s18 offen offset:1024 sc1 lds
buffer_load_dwordx4 v3, s[8:11], s18 offen offset:2048 sc1 lds
buffer_load_dwordx4 v3, s[8:11], s18 offen offset:3072 sc1 lds
s_add_u32 s18, s18, 32768
s_cmp_lg_u32 s16, 1
s_cbranch_scc1 Lfl_skip
s_mov_b64 exec, 65535
buffer_store_dwordx2 v[238:239], v237, s[68:71], 0 offen offset:512 sc1
s_mov_b64 exec, -1
Lfl_skip:
s_waitcnt vmcnt(16) lgkmcnt(0)
s_barrier
ds_read_b128 a[192:195], v1 offset:0
ds_read_b128 a[196:199], v1 offset:1024
ds_read_b128 a[200:203], v1 offset:2048
ds_read_b128 a[204:207], v1 offset:3072
ds_read_b128 a[208:211], v1 offset:4096
ds_read_b128 a[212:215], v1 offset:5120
ds_read_b128 a[216:219], v1 offset:6144
ds_read_b128 a[220:223], v1 offset:7168
s_add_u32 m0, s25, 65536
s_nop 0
buffer_load_dwordx4 v3, s[8:11], s19 offen offset:0 sc1 lds
buffer_load_dwordx4 v3, s[8:11], s19 offen offset:1024 sc1 lds
buffer_load_dwordx4 v3, s[8:11], s19 offen offset:2048 sc1 lds
buffer_load_dwordx4 v3, s[8:11], s19 offen offset:3072 sc1 lds
s_add_u32 s19, s19, 32768
s_waitcnt lgkmcnt(4)
v_mfma_f32_16x16x32_bf16 v[44:47], a[192:195], a[128:131], 0
v_mfma_f32_16x16x32_bf16 v[44:47], a[196:199], a[132:135], v[44:47]
v_mfma_f32_16x16x32_bf16 v[44:47], a[200:203], a[136:139], v[44:47]
v_mfma_f32_16x16x32_bf16 v[44:47], a[204:207], a[140:143], v[44:47]
ds_read_b128 a[224:227], v1 offset:8192
v_mfma_f32_16x16x32_bf16 v[48:51], a[204:207], a[156:159], 0
v_mfma_f32_16x16x32_bf16 v[48:51], a[200:203], a[152:155], v[48:51]
v_mfma_f32_16x16x32_bf16 v[48:51], a[196:199], a[148:151], v[48:51]
v_mfma_f32_16x16x32_bf16 v[48:51], a[192:195], a[144:147], v[48:51]
ds_read_b128 a[228:231], v1 offset:9216
v_mfma_f32_16x16x32_bf16 v[52:55], a[192:195], a[160:163], 0
v_mfma_f32_16x16x32_bf16 v[52:55], a[196:199], a[164:167], v[52:55]
v_mfma_f32_16x16x32_bf16 v[52:55], a[200:203], a[168:171], v[52:55]
v_mfma_f32_16x16x32_bf16 v[52:55], a[204:207], a[172:175], v[52:55]
ds_read_b128 a[232:235], v1 offset:10240
v_mfma_f32_16x16x32_bf16 v[56:59], a[204:207], a[188:191], 0
s_waitcnt lgkmcnt(3)
v_mfma_f32_16x16x32_bf16 v[56:59], a[200:203], a[184:187], v[56:59]
v_mfma_f32_16x16x32_bf16 v[56:59], a[196:199], a[180:183], v[56:59]
v_mfma_f32_16x16x32_bf16 v[56:59], a[192:195], a[176:179], v[56:59]
ds_read_b128 a[236:239], v1 offset:11264
v_mfma_f32_16x16x32_bf16 v[60:63], a[208:211], a[128:131], 0
v_mfma_f32_16x16x32_bf16 v[60:63], a[212:215], a[132:135], v[60:63]
v_mfma_f32_16x16x32_bf16 v[60:63], a[216:219], a[136:139], v[60:63]
v_mfma_f32_16x16x32_bf16 v[60:63], a[220:223], a[140:143], v[60:63]
ds_read_b128 a[240:243], v1 offset:12288
v_max3_f32 v20, v44, v45, v46
v_max3_f32 v21, v48, v49, v50
v_max3_f32 v22, v52, v53, v54
v_max3_f32 v23, v56, v57, v58
v_max_f32 v20, v20, v47
v_mfma_f32_16x16x32_bf16 v[64:67], a[220:223], a[156:159], 0
v_max_f32 v21, v21, v51
v_max_f32 v22, v22, v55
v_max_f32 v23, v23, v59
v_mov_b32 v24, v20
v_mfma_f32_16x16x32_bf16 v[64:67], a[216:219], a[152:155], v[64:67]
v_mov_b32 v25, v21
v_mov_b32 v26, v22
v_mov_b32 v27, v23
v_permlane32_swap_b32 v20, v24
v_permlane32_swap_b32 v21, v25
v_mfma_f32_16x16x32_bf16 v[64:67], a[212:215], a[148:151], v[64:67]
v_permlane32_swap_b32 v22, v26
v_permlane32_swap_b32 v23, v27
v_max_f32 v20, v20, v24
v_max_f32 v21, v21, v25
v_mfma_f32_16x16x32_bf16 v[64:67], a[208:211], a[144:147], v[64:67]
ds_read_b128 a[244:247], v1 offset:13312
v_max_f32 v22, v22, v26
v_max_f32 v23, v23, v27
v_mov_b32 v24, v20
v_mov_b32 v25, v21
v_mfma_f32_16x16x32_bf16 v[68:71], a[208:211], a[160:163], 0
v_mov_b32 v26, v22
v_mov_b32 v27, v23
v_permlane16_swap_b32 v20, v24
v_permlane16_swap_b32 v21, v25
v_permlane16_swap_b32 v22, v26
v_mfma_f32_16x16x32_bf16 v[68:71], a[212:215], a[164:167], v[68:71]
v_permlane16_swap_b32 v23, v27
v_max_f32 v20, v20, v24
v_max_f32 v21, v21, v25
v_max_f32 v22, v22, v26
v_mfma_f32_16x16x32_bf16 v[68:71], a[216:219], a[168:171], v[68:71]
v_max_f32 v23, v23, v27
v_sub_f32 v28, 0, v20
v_sub_f32 v32, 0, v21
v_sub_f32 v36, 0, v22
v_mfma_f32_16x16x32_bf16 v[68:71], a[220:223], a[172:175], v[68:71]
ds_read_b128 a[248:251], v1 offset:14336
v_sub_f32 v40, 0, v23
v_sub_f32 v29, 0, v20
v_sub_f32 v33, 0, v21
v_sub_f32 v37, 0, v22
v_sub_f32 v41, 0, v23
v_mfma_f32_16x16x32_bf16 v[72:75], a[220:223], a[188:191], 0
s_waitcnt lgkmcnt(3)
v_sub_f32 v30, 0, v20
v_sub_f32 v34, 0, v21
v_sub_f32 v38, 0, v22
v_sub_f32 v42, 0, v23
v_mfma_f32_16x16x32_bf16 v[72:75], a[216:219], a[184:187], v[72:75]
v_sub_f32 v31, 0, v20
v_sub_f32 v35, 0, v21
v_sub_f32 v39, 0, v22
v_sub_f32 v43, 0, v23
v_mfma_f32_16x16x32_bf16 v[72:75], a[212:215], a[180:183], v[72:75]
v_mfma_f32_16x16x32_bf16 v[72:75], a[208:211], a[176:179], v[72:75]
ds_read_b128 a[252:255], v1 offset:15360
v_mfma_f32_16x16x32_bf16 v[76:79], a[224:227], a[128:131], v[28:31]
v_add_f32 v44, v44, v28
v_add_f32 v45, v45, v28
v_exp_f32 v20, v44
v_mfma_f32_16x16x32_bf16 v[76:79], a[228:231], a[132:135], v[76:79]
v_exp_f32 v21, v45
v_mfma_f32_16x16x32_bf16 v[76:79], a[232:235], a[136:139], v[76:79]
v_add_f32 v46, v46, v28
v_add_f32 v47, v47, v28
v_exp_f32 v22, v46
v_mfma_f32_16x16x32_bf16 v[76:79], a[236:239], a[140:143], v[76:79]
ds_read_b128 a[192:195], v1 offset:16384
v_add_f32 v8, v20, v21
v_mfma_f32_16x16x32_bf16 v[80:83], a[236:239], a[156:159], v[32:35]
v_exp_f32 v23, v47
v_cvt_pk_bf16_f32 v172, v20, v21
v_mfma_f32_16x16x32_bf16 v[80:83], a[232:235], a[152:155], v[80:83]
v_add_f32 v48, v48, v32
v_add_f32 v49, v49, v32
v_exp_f32 v24, v48
v_mfma_f32_16x16x32_bf16 v[80:83], a[228:231], a[148:151], v[80:83]
v_add_f32 v8, v8, v22
v_add_f32 v8, v8, v23
v_exp_f32 v25, v49
v_mfma_f32_16x16x32_bf16 v[80:83], a[224:227], a[144:147], v[80:83]
ds_read_b128 a[196:199], v1 offset:17408
v_cvt_pk_bf16_f32 v173, v22, v23
v_mfma_f32_16x16x32_bf16 v[84:87], a[224:227], a[160:163], v[36:39]
v_add_f32 v50, v50, v32
v_add_f32 v51, v51, v32
v_exp_f32 v26, v50
v_add_f32 v9, v24, v25
v_mfma_f32_16x16x32_bf16 v[84:87], a[228:231], a[164:167], v[84:87]
v_exp_f32 v27, v51
v_mfma_f32_16x16x32_bf16 v[84:87], a[232:235], a[168:171], v[84:87]
v_cvt_pk_bf16_f32 v176, v24, v25
v_add_f32 v52, v52, v36
v_add_f32 v53, v53, v36
v_exp_f32 v20, v52
v_mfma_f32_16x16x32_bf16 v[84:87], a[236:239], a[172:175], v[84:87]
ds_read_b128 a[200:203], v1 offset:18432
v_add_f32 v9, v9, v26
v_add_f32 v9, v9, v27
v_mfma_f32_16x16x32_bf16 v[88:91], a[236:239], a[188:191], v[40:43]
s_waitcnt lgkmcnt(3)
v_exp_f32 v21, v53
v_mfma_f32_16x16x32_bf16 v[88:91], a[232:235], a[184:187], v[88:91]
v_cvt_pk_bf16_f32 v177, v26, v27
v_add_f32 v54, v54, v36
v_add_f32 v55, v55, v36
v_exp_f32 v22, v54
v_mfma_f32_16x16x32_bf16 v[88:91], a[228:231], a[180:183], v[88:91]
v_add_f32 v10, v20, v21
v_mfma_f32_16x16x32_bf16 v[88:91], a[224:227], a[176:179], v[88:91]
ds_read_b128 a[204:207], v1 offset:19456
v_exp_f32 v23, v55
v_cvt_pk_bf16_f32 v180, v20, v21
v_mfma_f32_16x16x32_bf16 v[92:95], a[240:243], a[128:131], v[28:31]
v_add_f32 v56, v56, v40
v_add_f32 v57, v57, v40
v_exp_f32 v24, v56
v_mfma_f32_16x16x32_bf16 v[92:95], a[244:247], a[132:135], v[92:95]
v_add_f32 v10, v10, v22
v_add_f32 v10, v10, v23
v_exp_f32 v25, v57
v_mfma_f32_16x16x32_bf16 v[92:95], a[248:251], a[136:139], v[92:95]
v_cvt_pk_bf16_f32 v181, v22, v23
v_mfma_f32_16x16x32_bf16 v[92:95], a[252:255], a[140:143], v[92:95]
ds_read_b128 a[208:211], v1 offset:20480
v_add_f32 v58, v58, v40
v_add_f32 v59, v59, v40
v_exp_f32 v26, v58
v_add_f32 v11, v24, v25
v_mfma_f32_16x16x32_bf16 v[96:99], a[252:255], a[156:159], v[32:35]
v_exp_f32 v27, v59
v_mfma_f32_16x16x32_bf16 v[96:99], a[248:251], a[152:155], v[96:99]
v_cvt_pk_bf16_f32 v184, v24, v25
v_add_f32 v60, v60, v28
v_add_f32 v61, v61, v28
v_exp_f32 v20, v60
v_mfma_f32_16x16x32_bf16 v[96:99], a[244:247], a[148:151], v[96:99]
v_add_f32 v11, v11, v26
v_add_f32 v11, v11, v27
v_mfma_f32_16x16x32_bf16 v[96:99], a[240:243], a[144:147], v[96:99]
ds_read_b128 a[212:215], v1 offset:21504
v_exp_f32 v21, v61
v_mfma_f32_16x16x32_bf16 v[100:103], a[240:243], a[160:163], v[36:39]
v_cvt_pk_bf16_f32 v185, v26, v27
v_add_f32 v62, v62, v28
v_add_f32 v63, v63, v28
v_exp_f32 v22, v62
v_mfma_f32_16x16x32_bf16 v[100:103], a[244:247], a[164:167], v[100:103]
v_add_f32 v8, v8, v20
v_add_f32 v8, v8, v21
v_mfma_f32_16x16x32_bf16 v[100:103], a[248:251], a[168:171], v[100:103]
v_exp_f32 v23, v63
v_cvt_pk_bf16_f32 v174, v20, v21
v_mfma_f32_16x16x32_bf16 v[100:103], a[252:255], a[172:175], v[100:103]
ds_read_b128 a[216:219], v1 offset:22528
v_add_f32 v64, v64, v32
v_add_f32 v65, v65, v32
v_exp_f32 v24, v64
v_mfma_f32_16x16x32_bf16 v[104:107], a[252:255], a[188:191], v[40:43]
s_waitcnt lgkmcnt(3)
v_add_f32 v8, v8, v22
v_add_f32 v8, v8, v23
v_exp_f32 v25, v65
v_mfma_f32_16x16x32_bf16 v[104:107], a[248:251], a[184:187], v[104:107]
v_cvt_pk_bf16_f32 v175, v22, v23
v_mfma_f32_16x16x32_bf16 v[104:107], a[244:247], a[180:183], v[104:107]
v_add_f32 v66, v66, v32
v_add_f32 v67, v67, v32
v_exp_f32 v26, v66
v_add_f32 v9, v9, v24
v_add_f32 v9, v9, v25
v_mfma_f32_16x16x32_bf16 v[104:107], a[240:243], a[176:179], v[104:107]
ds_read_b128 a[220:223], v1 offset:23552
v_exp_f32 v27, v67
v_mfma_f32_16x16x32_bf16 v[108:111], a[192:195], a[128:131], v[28:31]
v_cvt_pk_bf16_f32 v178, v24, v25
v_add_f32 v68, v68, v36
v_add_f32 v69, v69, v36
v_exp_f32 v20, v68
v_mfma_f32_16x16x32_bf16 v[108:111], a[196:199], a[132:135], v[108:111]
v_add_f32 v9, v9, v26
v_add_f32 v9, v9, v27
v_mfma_f32_16x16x32_bf16 v[108:111], a[200:203], a[136:139], v[108:111]
v_exp_f32 v21, v69
v_cvt_pk_bf16_f32 v179, v26, v27
v_mfma_f32_16x16x32_bf16 v[108:111], a[204:207], a[140:143], v[108:111]
ds_read_b128 a[224:227], v1 offset:24576
v_add_f32 v70, v70, v36
v_add_f32 v71, v71, v36
v_exp_f32 v22, v70
v_mfma_f32_16x16x32_bf16 v[112:115], a[204:207], a[156:159], v[32:35]
v_add_f32 v10, v10, v20
v_add_f32 v10, v10, v21
v_mfma_f32_16x16x32_bf16 v[112:115], a[200:203], a[152:155], v[112:115]
v_exp_f32 v23, v71
v_cvt_pk_bf16_f32 v182, v20, v21
v_mfma_f32_16x16x32_bf16 v[112:115], a[196:199], a[148:151], v[112:115]
v_add_f32 v72, v72, v40
v_add_f32 v73, v73, v40
v_exp_f32 v24, v72
v_mfma_f32_16x16x32_bf16 v[112:115], a[192:195], a[144:147], v[112:115]
ds_read_b128 a[228:231], v1 offset:25600
v_add_f32 v10, v10, v22
v_add_f32 v10, v10, v23
v_exp_f32 v25, v73
v_mfma_f32_16x16x32_bf16 v[116:119], a[192:195], a[160:163], v[36:39]
v_cvt_pk_bf16_f32 v183, v22, v23
v_mfma_f32_16x16x32_bf16 v[116:119], a[196:199], a[164:167], v[116:119]
v_add_f32 v74, v74, v40
v_add_f32 v75, v75, v40
v_exp_f32 v26, v74
v_add_f32 v11, v11, v24
v_add_f32 v11, v11, v25
v_mfma_f32_16x16x32_bf16 v[116:119], a[200:203], a[168:171], v[116:119]
v_exp_f32 v27, v75
v_mfma_f32_16x16x32_bf16 v[116:119], a[204:207], a[172:175], v[116:119]
ds_read_b128 a[232:235], v1 offset:26624
v_cvt_pk_bf16_f32 v186, v24, v25
v_exp_f32 v20, v76
v_mfma_f32_16x16x32_bf16 v[120:123], a[204:207], a[188:191], v[40:43]
s_waitcnt lgkmcnt(3)
v_add_f32 v11, v11, v26
v_add_f32 v11, v11, v27
v_mfma_f32_16x16x32_bf16 v[120:123], a[200:203], a[184:187], v[120:123]
v_exp_f32 v21, v77
v_cvt_pk_bf16_f32 v187, v26, v27
v_mfma_f32_16x16x32_bf16 v[120:123], a[196:199], a[180:183], v[120:123]
v_exp_f32 v22, v78
v_mfma_f32_16x16x32_bf16 v[120:123], a[192:195], a[176:179], v[120:123]
ds_read_b128 a[236:239], v1 offset:27648
v_add_f32 v8, v8, v20
v_add_f32 v8, v8, v21
v_mfma_f32_16x16x32_bf16 v[124:127], a[208:211], a[128:131], v[28:31]
v_exp_f32 v23, v79
v_cvt_pk_bf16_f32 v188, v20, v21
v_mfma_f32_16x16x32_bf16 v[124:127], a[212:215], a[132:135], v[124:127]
v_exp_f32 v24, v80
v_mfma_f32_16x16x32_bf16 v[124:127], a[216:219], a[136:139], v[124:127]
v_add_f32 v8, v8, v22
v_add_f32 v8, v8, v23
v_exp_f32 v25, v81
v_mfma_f32_16x16x32_bf16 v[124:127], a[220:223], a[140:143], v[124:127]
ds_read_b128 a[240:243], v1 offset:28672
v_cvt_pk_bf16_f32 v189, v22, v23
v_mfma_f32_16x16x32_bf16 v[128:131], a[220:223], a[156:159], v[32:35]
v_exp_f32 v26, v82
v_add_f32 v9, v9, v24
v_add_f32 v9, v9, v25
v_mfma_f32_16x16x32_bf16 v[128:131], a[216:219], a[152:155], v[128:131]
v_exp_f32 v27, v83
v_mfma_f32_16x16x32_bf16 v[128:131], a[212:215], a[148:151], v[128:131]
v_cvt_pk_bf16_f32 v192, v24, v25
v_exp_f32 v20, v84
v_mfma_f32_16x16x32_bf16 v[128:131], a[208:211], a[144:147], v[128:131]
ds_read_b128 a[244:247], v1 offset:29696
v_add_f32 v9, v9, v26
v_add_f32 v9, v9, v27
v_mfma_f32_16x16x32_bf16 v[132:135], a[208:211], a[160:163], v[36:39]
v_exp_f32 v21, v85
v_cvt_pk_bf16_f32 v193, v26, v27
v_mfma_f32_16x16x32_bf16 v[132:135], a[212:215], a[164:167], v[132:135]
v_exp_f32 v22, v86
v_mfma_f32_16x16x32_bf16 v[132:135], a[216:219], a[168:171], v[132:135]
v_add_f32 v10, v10, v20
v_add_f32 v10, v10, v21
v_exp_f32 v23, v87
v_mfma_f32_16x16x32_bf16 v[132:135], a[220:223], a[172:175], v[132:135]
ds_read_b128 a[248:251], v1 offset:30720
v_cvt_pk_bf16_f32 v196, v20, v21
v_mfma_f32_16x16x32_bf16 v[136:139], a[220:223], a[188:191], v[40:43]
s_waitcnt lgkmcnt(3)
v_exp_f32 v24, v88
v_mfma_f32_16x16x32_bf16 v[136:139], a[216:219], a[184:187], v[136:139]
s_waitcnt vmcnt(12)
v_add_f32 v10, v10, v22
v_add_f32 v10, v10, v23
v_exp_f32 v25, v89
v_mfma_f32_16x16x32_bf16 v[136:139], a[212:215], a[180:183], v[136:139]
s_barrier
v_cvt_pk_bf16_f32 v197, v22, v23
v_mfma_f32_16x16x32_bf16 v[136:139], a[208:211], a[176:179], v[136:139]
ds_read_b128 a[252:255], v1 offset:31744
v_exp_f32 v26, v90
v_add_f32 v11, v11, v24
v_add_f32 v11, v11, v25
v_mfma_f32_16x16x32_bf16 v[140:143], a[224:227], a[128:131], v[28:31]
v_exp_f32 v27, v91
v_mfma_f32_16x16x32_bf16 v[140:143], a[228:231], a[132:135], v[140:143]
v_cvt_pk_bf16_f32 v200, v24, v25
v_exp_f32 v20, v92
v_mfma_f32_16x16x32_bf16 v[140:143], a[232:235], a[136:139], v[140:143]
v_add_f32 v11, v11, v26
v_add_f32 v11, v11, v27
v_mfma_f32_16x16x32_bf16 v[140:143], a[236:239], a[140:143], v[140:143]
ds_read_b128 a[192:195], v2 offset:0
v_exp_f32 v21, v93
v_cvt_pk_bf16_f32 v201, v26, v27
v_mfma_f32_16x16x32_bf16 v[144:147], a[236:239], a[156:159], v[32:35]
v_exp_f32 v22, v94
v_mfma_f32_16x16x32_bf16 v[144:147], a[232:235], a[152:155], v[144:147]
v_add_f32 v8, v8, v20
v_add_f32 v8, v8, v21
v_exp_f32 v23, v95
v_mfma_f32_16x16x32_bf16 v[144:147], a[228:231], a[148:151], v[144:147]
v_cvt_pk_bf16_f32 v190, v20, v21
v_mfma_f32_16x16x32_bf16 v[144:147], a[224:227], a[144:147], v[144:147]
ds_read_b128 a[196:199], v2 offset:8192
v_exp_f32 v24, v96
v_mfma_f32_16x16x32_bf16 v[148:151], a[224:227], a[160:163], v[36:39]
v_add_f32 v8, v8, v22
v_add_f32 v8, v8, v23
v_exp_f32 v25, v97
v_mfma_f32_16x16x32_bf16 v[148:151], a[228:231], a[164:167], v[148:151]
v_cvt_pk_bf16_f32 v191, v22, v23
v_mfma_f32_16x16x32_bf16 v[148:151], a[232:235], a[168:171], v[148:151]
v_exp_f32 v26, v98
v_add_f32 v9, v9, v24
v_add_f32 v9, v9, v25
v_mfma_f32_16x16x32_bf16 v[148:151], a[236:239], a[172:175], v[148:151]
ds_read_b128 a[200:203], v2 offset:1024
v_exp_f32 v27, v99
v_mfma_f32_16x16x32_bf16 v[152:155], a[236:239], a[188:191], v[40:43]
s_waitcnt lgkmcnt(3)
v_cvt_pk_bf16_f32 v194, v24, v25
v_exp_f32 v20, v100
v_mfma_f32_16x16x32_bf16 v[152:155], a[232:235], a[184:187], v[152:155]
v_add_f32 v9, v9, v26
v_add_f32 v9, v9, v27
v_mfma_f32_16x16x32_bf16 v[152:155], a[228:231], a[180:183], v[152:155]
v_exp_f32 v21, v101
v_cvt_pk_bf16_f32 v195, v26, v27
v_mfma_f32_16x16x32_bf16 v[152:155], a[224:227], a[176:179], v[152:155]
ds_read_b128 a[204:207], v2 offset:9216
v_exp_f32 v22, v102
v_mfma_f32_16x16x32_bf16 v[156:159], a[240:243], a[128:131], v[28:31]
v_add_f32 v10, v10, v20
v_add_f32 v10, v10, v21
v_exp_f32 v23, v103
v_mfma_f32_16x16x32_bf16 v[156:159], a[244:247], a[132:135], v[156:159]
v_cvt_pk_bf16_f32 v198, v20, v21
v_xor_b32 v1, 0x8000, v1
v_mfma_f32_16x16x32_bf16 v[156:159], a[248:251], a[136:139], v[156:159]
v_exp_f32 v24, v104
v_add_f32 v10, v10, v22
v_add_f32 v10, v10, v23
v_mfma_f32_16x16x32_bf16 v[156:159], a[252:255], a[140:143], v[156:159]
ds_read_b128 a[208:211], v2 offset:2048
v_exp_f32 v25, v105
v_mfma_f32_16x16x32_bf16 v[160:163], a[252:255], a[156:159], v[32:35]
v_cvt_pk_bf16_f32 v199, v22, v23
v_mfma_f32_16x16x32_bf16 v[160:163], a[248:251], a[152:155], v[160:163]
v_exp_f32 v26, v106
v_add_f32 v11, v11, v24
v_add_f32 v11, v11, v25
v_mfma_f32_16x16x32_bf16 v[160:163], a[244:247], a[148:151], v[160:163]
v_exp_f32 v27, v107
v_mfma_f32_16x16x32_bf16 v[160:163], a[240:243], a[144:147], v[160:163]
ds_read_b128 a[212:215], v2 offset:10240
v_cvt_pk_bf16_f32 v202, v24, v25
v_exp_f32 v20, v108
v_mfma_f32_16x16x32_bf16 v[164:167], a[240:243], a[160:163], v[36:39]
v_add_f32 v11, v11, v26
v_add_f32 v11, v11, v27
v_mfma_f32_16x16x32_bf16 v[164:167], a[244:247], a[164:167], v[164:167]
v_exp_f32 v21, v109
v_cvt_pk_bf16_f32 v203, v26, v27
v_mfma_f32_16x16x32_bf16 v[164:167], a[248:251], a[168:171], v[164:167]
v_exp_f32 v22, v110
v_mfma_f32_16x16x32_bf16 v[164:167], a[252:255], a[172:175], v[164:167]
ds_read_b128 a[216:219], v2 offset:3072
v_add_f32 v12, v20, v21
v_max3_f32 v7, v8, v9, v10
v_exp_f32 v23, v111
v_max_f32 v7, v7, v11
v_mfma_f32_16x16x32_bf16 v[168:171], a[252:255], a[188:191], v[40:43]
s_waitcnt lgkmcnt(5)
v_cvt_pk_bf16_f32 v204, v20, v21
v_cmp_nge_f32 vcc, s21, v7
v_mfma_f32_16x16x32_bf16 v[168:171], a[248:251], a[184:187], v[168:171]
v_exp_f32 v24, v112
v_add_f32 v12, v12, v22
v_add_f32 v12, v12, v23
v_mfma_f32_16x16x32_bf16 v[168:171], a[244:247], a[180:183], v[168:171]
v_exp_f32 v25, v113
v_mfma_f32_16x16x32_bf16 v[168:171], a[240:243], a[176:179], v[168:171]
ds_read_b128 a[220:223], v2 offset:11264
v_cvt_pk_bf16_f32 v205, v22, v23
s_cbranch_vccnz Ltr_p0
Lbk_p0:
s_cmp_lg_u32 s16, 1
s_cbranch_scc1 LB_ns
buffer_load_dwordx2 v[240:241], v236, s[68:71], 0 offen offset:512 sc1
LB_ns:
s_mov_b32 s20, 15
.p2align 6
Lloop:
v_mfma_f32_16x16x32_bf16 a[0:3], v[172:175], a[192:195], a[0:3]
v_exp_f32 v26, v114
v_mfma_f32_16x16x32_bf16 a[0:3], v[188:191], a[196:199], a[0:3]
v_add_f32 v13, v24, v25
v_add_f32 v16, v16, v8
v_mfma_f32_16x16x32_bf16 a[4:7], v[192:195], a[196:199], a[4:7]
v_exp_f32 v27, v115
v_mfma_f32_16x16x32_bf16 a[4:7], v[176:179], a[192:195], a[4:7]
ds_read_b128 a[224:227], v2 offset:4096
v_cvt_pk_bf16_f32 v208, v24, v25
v_mfma_f32_16x16x32_bf16 a[8:11], v[180:183], a[192:195], a[8:11]
s_waitcnt lgkmcnt(5)
v_exp_f32 v20, v116
v_mfma_f32_16x16x32_bf16 a[8:11], v[196:199], a[196:199], a[8:11]
s_add_u32 m0, s25, 81920
v_add_f32 v13, v13, v26
v_add_f32 v13, v13, v27
v_mfma_f32_16x16x32_bf16 a[12:15], v[200:203], a[196:199], a[12:15]
buffer_load_dwordx4 v3, s[8:11], s19 offen offset:0 sc1 lds
v_exp_f32 v21, v117
v_mfma_f32_16x16x32_bf16 a[12:15], v[184:187], a[192:195], a[12:15]
ds_read_b128 a[228:231], v2 offset:12288
v_cvt_pk_bf16_f32 v209, v26, v27
v_mfma_f32_16x16x32_bf16 a[16:19], v[172:175], a[200:203], a[16:19]
v_exp_f32 v22, v118
v_mfma_f32_16x16x32_bf16 a[16:19], v[188:191], a[204:207], a[16:19]
v_add_f32 v14, v20, v21
v_add_f32 v17, v17, v9
v_mfma_f32_16x16x32_bf16 a[20:23], v[192:195], a[204:207], a[20:23]
v_exp_f32 v23, v119
v_mfma_f32_16x16x32_bf16 a[20:23], v[176:179], a[200:203], a[20:23]
ds_read_b128 a[232:235], v2 offset:5120
v_cvt_pk_bf16_f32 v212, v20, v21
v_mfma_f32_16x16x32_bf16 a[24:27], v[180:183], a[200:203], a[24:27]
s_waitcnt lgkmcnt(5)
v_exp_f32 v24, v120
v_mfma_f32_16x16x32_bf16 a[24:27], v[196:199], a[204:207], a[24:27]
v_add_f32 v14, v14, v22
v_add_f32 v14, v14, v23
v_mfma_f32_16x16x32_bf16 a[28:31], v[200:203], a[204:207], a[28:31]
buffer_load_dwordx4 v3, s[8:11], s19 offen offset:1024 sc1 lds
v_exp_f32 v25, v121
v_mfma_f32_16x16x32_bf16 a[28:31], v[184:187], a[200:203], a[28:31]
ds_read_b128 a[236:239], v2 offset:13312
v_cvt_pk_bf16_f32 v213, v22, v23
v_mfma_f32_16x16x32_bf16 a[32:35], v[172:175], a[208:211], a[32:35]
v_exp_f32 v26, v122
v_mfma_f32_16x16x32_bf16 a[32:35], v[188:191], a[212:215], a[32:35]
v_add_f32 v15, v24, v25
v_add_f32 v18, v18, v10
v_mfma_f32_16x16x32_bf16 a[36:39], v[192:195], a[212:215], a[36:39]
v_exp_f32 v27, v123
v_mfma_f32_16x16x32_bf16 a[36:39], v[176:179], a[208:211], a[36:39]
ds_read_b128 a[240:243], v2 offset:6144
v_cvt_pk_bf16_f32 v216, v24, v25
v_mfma_f32_16x16x32_bf16 a[40:43], v[180:183], a[208:211], a[40:43]
s_waitcnt lgkmcnt(5)
v_exp_f32 v20, v124
v_mfma_f32_16x16x32_bf16 a[40:43], v[196:199], a[212:215], a[40:43]
v_add_f32 v15, v15, v26
v_add_f32 v15, v15, v27
v_mfma_f32_16x16x32_bf16 a[44:47], v[200:203], a[212:215], a[44:47]
buffer_load_dwordx4 v3, s[8:11], s19 offen offset:2048 sc1 lds
v_exp_f32 v21, v125
v_mfma_f32_16x16x32_bf16 a[44:47], v[184:187], a[208:211], a[44:47]
ds_read_b128 a[244:247], v2 offset:14336
v_cvt_pk_bf16_f32 v217, v26, v27
v_mfma_f32_16x16x32_bf16 a[48:51], v[172:175], a[216:219], a[48:51]
v_exp_f32 v22, v126
v_mfma_f32_16x16x32_bf16 a[48:51], v[188:191], a[220:223], a[48:51]
v_add_f32 v12, v12, v20
v_add_f32 v12, v12, v21
v_mfma_f32_16x16x32_bf16 a[52:55], v[192:195], a[220:223], a[52:55]
v_exp_f32 v23, v127
v_mfma_f32_16x16x32_bf16 a[52:55], v[176:179], a[216:219], a[52:55]
ds_read_b128 a[248:251], v2 offset:7168
v_cvt_pk_bf16_f32 v206, v20, v21
v_mfma_f32_16x16x32_bf16 a[56:59], v[180:183], a[216:219], a[56:59]
s_waitcnt lgkmcnt(5)
v_exp_f32 v24, v128
v_mfma_f32_16x16x32_bf16 a[56:59], v[196:199], a[220:223], a[56:59]
v_add_f32 v12, v12, v22
v_add_f32 v12, v12, v23
v_mfma_f32_16x16x32_bf16 a[60:63], v[200:203], a[220:223], a[60:63]
buffer_load_dwordx4 v3, s[8:11], s19 offen offset:3072 sc1 lds
v_exp_f32 v25, v129
v_mfma_f32_16x16x32_bf16 a[60:63], v[184:187], a[216:219], a[60:63]
ds_read_b128 a[252:255], v2 offset:15360
v_cvt_pk_bf16_f32 v207, v22, v23
v_mfma_f32_16x16x32_bf16 a[64:67], v[172:175], a[224:227], a[64:67]
s_add_u32 s19, s19, 32768
v_exp_f32 v26, v130
v_mfma_f32_16x16x32_bf16 a[64:67], v[188:191], a[228:231], a[64:67]
v_add_f32 v13, v13, v24
v_add_f32 v13, v13, v25
v_mfma_f32_16x16x32_bf16 a[68:71], v[192:195], a[228:231], a[68:71]
v_exp_f32 v27, v131
v_mfma_f32_16x16x32_bf16 a[68:71], v[176:179], a[224:227], a[68:71]
ds_read_b128 a[192:195], v1 offset:0
v_cvt_pk_bf16_f32 v210, v24, v25
v_mfma_f32_16x16x32_bf16 a[72:75], v[180:183], a[224:227], a[72:75]
s_waitcnt lgkmcnt(5)
v_exp_f32 v20, v132
v_mfma_f32_16x16x32_bf16 a[72:75], v[196:199], a[228:231], a[72:75]
s_add_u32 m0, s24, 0
v_add_f32 v13, v13, v26
v_add_f32 v13, v13, v27
v_mfma_f32_16x16x32_bf16 a[76:79], v[200:203], a[228:231], a[76:79]
buffer_load_dwordx4 v3, s[8:11], s18 offen offset:0 sc1 lds
v_exp_f32 v21, v133
v_mfma_f32_16x16x32_bf16 a[76:79], v[184:187], a[224:227], a[76:79]
ds_read_b128 a[196:199], v1 offset:1024
v_cvt_pk_bf16_f32 v211, v26, v27
v_mfma_f32_16x16x32_bf16 a[80:83], v[172:175], a[232:235], a[80:83]
v_exp_f32 v22, v134
v_mfma_f32_16x16x32_bf16 a[80:83], v[188:191], a[236:239], a[80:83]
v_add_f32 v14, v14, v20
v_add_f32 v14, v14, v21
v_mfma_f32_16x16x32_bf16 a[84:87], v[192:195], a[236:239], a[84:87]
v_exp_f32 v23, v135
v_mfma_f32_16x16x32_bf16 a[84:87], v[176:179], a[232:235], a[84:87]
ds_read_b128 a[200:203], v1 offset:2048
v_cvt_pk_bf16_f32 v214, v20, v21
v_mfma_f32_16x16x32_bf16 a[88:91], v[180:183], a[232:235], a[88:91]
s_waitcnt lgkmcnt(5)
v_exp_f32 v24, v136
v_mfma_f32_16x16x32_bf16 a[88:91], v[196:199], a[236:239], a[88:91]
v_add_f32 v14, v14, v22
v_add_f32 v14, v14, v23
v_mfma_f32_16x16x32_bf16 a[92:95], v[200:203], a[236:239], a[92:95]
buffer_load_dwordx4 v3, s[8:11], s18 offen offset:1024 sc1 lds
v_exp_f32 v25, v137
v_mfma_f32_16x16x32_bf16 a[92:95], v[184:187], a[232:235], a[92:95]
ds_read_b128 a[204:207], v1 offset:3072
v_cvt_pk_bf16_f32 v215, v22, v23
v_mfma_f32_16x16x32_bf16 a[96:99], v[172:175], a[240:243], a[96:99]
v_exp_f32 v26, v138
v_mfma_f32_16x16x32_bf16 a[96:99], v[188:191], a[244:247], a[96:99]
v_add_f32 v15, v15, v24
v_add_f32 v15, v15, v25
v_mfma_f32_16x16x32_bf16 a[100:103], v[192:195], a[244:247], a[100:103]
v_exp_f32 v27, v139
v_mfma_f32_16x16x32_bf16 a[100:103], v[176:179], a[240:243], a[100:103]
ds_read_b128 a[208:211], v1 offset:4096
v_cvt_pk_bf16_f32 v218, v24, v25
v_mfma_f32_16x16x32_bf16 a[104:107], v[180:183], a[240:243], a[104:107]
s_waitcnt lgkmcnt(5)
v_exp_f32 v20, v140
v_mfma_f32_16x16x32_bf16 a[104:107], v[196:199], a[244:247], a[104:107]
v_add_f32 v15, v15, v26
v_add_f32 v15, v15, v27
v_mfma_f32_16x16x32_bf16 a[108:111], v[200:203], a[244:247], a[108:111]
buffer_load_dwordx4 v3, s[8:11], s18 offen offset:2048 sc1 lds
v_exp_f32 v21, v141
v_mfma_f32_16x16x32_bf16 a[108:111], v[184:187], a[240:243], a[108:111]
ds_read_b128 a[212:215], v1 offset:5120
v_cvt_pk_bf16_f32 v219, v26, v27
v_mfma_f32_16x16x32_bf16 a[112:115], v[172:175], a[248:251], a[112:115]
v_exp_f32 v22, v142
v_mfma_f32_16x16x32_bf16 a[112:115], v[188:191], a[252:255], a[112:115]
v_add_f32 v12, v12, v20
v_add_f32 v12, v12, v21
v_mfma_f32_16x16x32_bf16 a[116:119], v[192:195], a[252:255], a[116:119]
v_exp_f32 v23, v143
v_mfma_f32_16x16x32_bf16 a[116:119], v[176:179], a[248:251], a[116:119]
ds_read_b128 a[216:219], v1 offset:6144
v_cvt_pk_bf16_f32 v220, v20, v21
v_mfma_f32_16x16x32_bf16 a[120:123], v[180:183], a[248:251], a[120:123]
s_waitcnt lgkmcnt(3)
v_exp_f32 v24, v144
v_mfma_f32_16x16x32_bf16 a[120:123], v[196:199], a[252:255], a[120:123]
v_add_f32 v12, v12, v22
v_add_f32 v12, v12, v23
v_mfma_f32_16x16x32_bf16 a[124:127], v[200:203], a[252:255], a[124:127]
buffer_load_dwordx4 v3, s[8:11], s18 offen offset:3072 sc1 lds
v_exp_f32 v25, v145
v_mfma_f32_16x16x32_bf16 a[124:127], v[184:187], a[248:251], a[124:127]
ds_read_b128 a[220:223], v1 offset:7168
v_cvt_pk_bf16_f32 v221, v22, v23
v_mfma_f32_16x16x32_bf16 v[44:47], a[192:195], a[128:131], v[28:31]
s_add_u32 s18, s18, 32768
v_exp_f32 v26, v146
v_mfma_f32_16x16x32_bf16 v[44:47], a[196:199], a[132:135], v[44:47]
v_add_f32 v13, v13, v24
v_add_f32 v13, v13, v25
v_mfma_f32_16x16x32_bf16 v[44:47], a[200:203], a[136:139], v[44:47]
v_exp_f32 v27, v147
v_mfma_f32_16x16x32_bf16 v[44:47], a[204:207], a[140:143], v[44:47]
ds_read_b128 a[224:227], v1 offset:8192
v_cvt_pk_bf16_f32 v224, v24, v25
v_mfma_f32_16x16x32_bf16 v[48:51], a[204:207], a[156:159], v[32:35]
v_exp_f32 v20, v148
v_mfma_f32_16x16x32_bf16 v[48:51], a[200:203], a[152:155], v[48:51]
v_add_f32 v13, v13, v26
v_add_f32 v13, v13, v27
v_mfma_f32_16x16x32_bf16 v[48:51], a[196:199], a[148:151], v[48:51]
v_exp_f32 v21, v149
v_mfma_f32_16x16x32_bf16 v[48:51], a[192:195], a[144:147], v[48:51]
ds_read_b128 a[228:231], v1 offset:9216
v_cvt_pk_bf16_f32 v225, v26, v27
v_mfma_f32_16x16x32_bf16 v[52:55], a[192:195], a[160:163], v[36:39]
v_exp_f32 v22, v150
v_mfma_f32_16x16x32_bf16 v[52:55], a[196:199], a[164:167], v[52:55]
v_add_f32 v14, v14, v20
v_add_f32 v14, v14, v21
v_mfma_f32_16x16x32_bf16 v[52:55], a[200:203], a[168:171], v[52:55]
v_exp_f32 v23, v151
v_mfma_f32_16x16x32_bf16 v[52:55], a[204:207], a[172:175], v[52:55]
ds_read_b128 a[232:235], v1 offset:10240
v_cvt_pk_bf16_f32 v228, v20, v21
v_mfma_f32_16x16x32_bf16 v[56:59], a[204:207], a[188:191], v[40:43]
s_waitcnt lgkmcnt(3)
v_exp_f32 v24, v152
v_mfma_f32_16x16x32_bf16 v[56:59], a[200:203], a[184:187], v[56:59]
v_add_f32 v14, v14, v22
v_add_f32 v14, v14, v23
v_mfma_f32_16x16x32_bf16 v[56:59], a[196:199], a[180:183], v[56:59]
v_exp_f32 v25, v153
v_mfma_f32_16x16x32_bf16 v[56:59], a[192:195], a[176:179], v[56:59]
ds_read_b128 a[236:239], v1 offset:11264
v_cvt_pk_bf16_f32 v229, v22, v23
v_mfma_f32_16x16x32_bf16 v[60:63], a[208:211], a[128:131], v[28:31]
v_exp_f32 v26, v154
v_mfma_f32_16x16x32_bf16 v[60:63], a[212:215], a[132:135], v[60:63]
v_add_f32 v15, v15, v24
v_add_f32 v15, v15, v25
v_mfma_f32_16x16x32_bf16 v[60:63], a[216:219], a[136:139], v[60:63]
v_exp_f32 v27, v155
v_mfma_f32_16x16x32_bf16 v[60:63], a[220:223], a[140:143], v[60:63]
ds_read_b128 a[240:243], v1 offset:12288
v_cvt_pk_bf16_f32 v232, v24, v25
v_mfma_f32_16x16x32_bf16 v[64:67], a[220:223], a[156:159], v[32:35]
v_exp_f32 v20, v156
v_mfma_f32_16x16x32_bf16 v[64:67], a[216:219], a[152:155], v[64:67]
v_add_f32 v15, v15, v26
v_add_f32 v15, v15, v27
v_mfma_f32_16x16x32_bf16 v[64:67], a[212:215], a[148:151], v[64:67]
v_exp_f32 v21, v157
v_mfma_f32_16x16x32_bf16 v[64:67], a[208:211], a[144:147], v[64:67]
ds_read_b128 a[244:247], v1 offset:13312
v_cvt_pk_bf16_f32 v233, v26, v27
v_mfma_f32_16x16x32_bf16 v[68:71], a[208:211], a[160:163], v[36:39]
v_exp_f32 v22, v158
v_mfma_f32_16x16x32_bf16 v[68:71], a[212:215], a[164:167], v[68:71]
v_add_f32 v12, v12, v20
v_add_f32 v12, v12, v21
v_mfma_f32_16x16x32_bf16 v[68:71], a[216:219], a[168:171], v[68:71]
v_exp_f32 v23, v159
v_mfma_f32_16x16x32_bf16 v[68:71], a[220:223], a[172:175], v[68:71]
ds_read_b128 a[248:251], v1 offset:14336
v_cvt_pk_bf16_f32 v222, v20, v21
v_mfma_f32_16x16x32_bf16 v[72:75], a[220:223], a[188:191], v[40:43]
s_waitcnt lgkmcnt(3)
v_exp_f32 v24, v160
v_mfma_f32_16x16x32_bf16 v[72:75], a[216:219], a[184:187], v[72:75]
s_waitcnt vmcnt(8)
v_add_f32 v12, v12, v22
v_add_f32 v12, v12, v23
v_mfma_f32_16x16x32_bf16 v[72:75], a[212:215], a[180:183], v[72:75]
s_barrier
v_exp_f32 v25, v161
v_mfma_f32_16x16x32_bf16 v[72:75], a[208:211], a[176:179], v[72:75]
ds_read_b128 a[252:255], v1 offset:15360
v_cvt_pk_bf16_f32 v223, v22, v23
v_mfma_f32_16x16x32_bf16 v[76:79], a[224:227], a[128:131], v[28:31]
v_exp_f32 v26, v162
v_mfma_f32_16x16x32_bf16 v[76:79], a[228:231], a[132:135], v[76:79]
v_add_f32 v13, v13, v24
v_add_f32 v13, v13, v25
v_mfma_f32_16x16x32_bf16 v[76:79], a[232:235], a[136:139], v[76:79]
v_exp_f32 v27, v163
v_mfma_f32_16x16x32_bf16 v[76:79], a[236:239], a[140:143], v[76:79]
ds_read_b128 a[192:195], v2 offset:16384
v_cvt_pk_bf16_f32 v226, v24, v25
v_mfma_f32_16x16x32_bf16 v[80:83], a[236:239], a[156:159], v[32:35]
v_exp_f32 v20, v164
v_mfma_f32_16x16x32_bf16 v[80:83], a[232:235], a[152:155], v[80:83]
v_add_f32 v13, v13, v26
v_add_f32 v13, v13, v27
v_mfma_f32_16x16x32_bf16 v[80:83], a[228:231], a[148:151], v[80:83]
v_exp_f32 v21, v165
v_mfma_f32_16x16x32_bf16 v[80:83], a[224:227], a[144:147], v[80:83]
ds_read_b128 a[196:199], v2 offset:24576
v_cvt_pk_bf16_f32 v227, v26, v27
v_mfma_f32_16x16x32_bf16 v[84:87], a[224:227], a[160:163], v[36:39]
v_exp_f32 v22, v166
v_mfma_f32_16x16x32_bf16 v[84:87], a[228:231], a[164:167], v[84:87]
v_add_f32 v14, v14, v20
v_add_f32 v14, v14, v21
v_mfma_f32_16x16x32_bf16 v[84:87], a[232:235], a[168:171], v[84:87]
v_exp_f32 v23, v167
v_mfma_f32_16x16x32_bf16 v[84:87], a[236:239], a[172:175], v[84:87]
ds_read_b128 a[200:203], v2 offset:17408
v_cvt_pk_bf16_f32 v230, v20, v21
v_mfma_f32_16x16x32_bf16 v[88:91], a[236:239], a[188:191], v[40:43]
s_waitcnt lgkmcnt(3)
v_exp_f32 v24, v168
v_mfma_f32_16x16x32_bf16 v[88:91], a[232:235], a[184:187], v[88:91]
v_add_f32 v14, v14, v22
v_add_f32 v14, v14, v23
v_mfma_f32_16x16x32_bf16 v[88:91], a[228:231], a[180:183], v[88:91]
v_exp_f32 v25, v169
v_mfma_f32_16x16x32_bf16 v[88:91], a[224:227], a[176:179], v[88:91]
ds_read_b128 a[204:207], v2 offset:25600
v_cvt_pk_bf16_f32 v231, v22, v23
v_mfma_f32_16x16x32_bf16 v[92:95], a[240:243], a[128:131], v[28:31]
v_exp_f32 v26, v170
v_mfma_f32_16x16x32_bf16 v[92:95], a[244:247], a[132:135], v[92:95]
v_add_f32 v15, v15, v24
v_add_f32 v15, v15, v25
v_mfma_f32_16x16x32_bf16 v[92:95], a[248:251], a[136:139], v[92:95]
v_exp_f32 v27, v171
v_mfma_f32_16x16x32_bf16 v[92:95], a[252:255], a[140:143], v[92:95]
ds_read_b128 a[208:211], v2 offset:18432
v_cvt_pk_bf16_f32 v234, v24, v25
v_mfma_f32_16x16x32_bf16 v[96:99], a[252:255], a[156:159], v[32:35]
v_exp_f32 v20, v44
v_mfma_f32_16x16x32_bf16 v[96:99], a[248:251], a[152:155], v[96:99]
v_add_f32 v15, v15, v26
v_add_f32 v15, v15, v27
v_mfma_f32_16x16x32_bf16 v[96:99], a[244:247], a[148:151], v[96:99]
v_exp_f32 v21, v45
v_mfma_f32_16x16x32_bf16 v[96:99], a[240:243], a[144:147], v[96:99]
ds_read_b128 a[212:215], v2 offset:26624
v_cvt_pk_bf16_f32 v235, v26, v27
v_mfma_f32_16x16x32_bf16 v[100:103], a[240:243], a[160:163], v[36:39]
v_exp_f32 v22, v46
v_mfma_f32_16x16x32_bf16 v[100:103], a[244:247], a[164:167], v[100:103]
v_add_f32 v8, v20, v21
v_add_f32 v19, v19, v11
v_max3_f32 v7, v12, v13, v14
v_mfma_f32_16x16x32_bf16 v[100:103], a[248:251], a[168:171], v[100:103]
v_exp_f32 v23, v47
v_max_f32 v7, v7, v15
v_mfma_f32_16x16x32_bf16 v[100:103], a[252:255], a[172:175], v[100:103]
ds_read_b128 a[216:219], v2 offset:19456
v_cvt_pk_bf16_f32 v172, v20, v21
v_cmp_nge_f32 vcc, s21, v7
v_mfma_f32_16x16x32_bf16 v[104:107], a[252:255], a[188:191], v[40:43]
s_waitcnt lgkmcnt(5)
v_exp_f32 v24, v48
v_mfma_f32_16x16x32_bf16 v[104:107], a[248:251], a[184:187], v[104:107]
v_add_f32 v8, v8, v22
v_add_f32 v8, v8, v23
v_mfma_f32_16x16x32_bf16 v[104:107], a[244:247], a[180:183], v[104:107]
v_exp_f32 v25, v49
v_mfma_f32_16x16x32_bf16 v[104:107], a[240:243], a[176:179], v[104:107]
ds_read_b128 a[220:223], v2 offset:27648
v_cvt_pk_bf16_f32 v173, v22, v23
s_cbranch_vccnz Ltr_l1
Lbk_l1:
v_mfma_f32_16x16x32_bf16 a[0:3], v[204:207], a[192:195], a[0:3]
v_exp_f32 v26, v50
v_mfma_f32_16x16x32_bf16 a[0:3], v[220:223], a[196:199], a[0:3]
v_add_f32 v9, v24, v25
v_add_f32 v16, v16, v12
v_mfma_f32_16x16x32_bf16 a[4:7], v[224:227], a[196:199], a[4:7]
v_exp_f32 v27, v51
v_mfma_f32_16x16x32_bf16 a[4:7], v[208:211], a[192:195], a[4:7]
ds_read_b128 a[224:227], v2 offset:20480
v_cvt_pk_bf16_f32 v176, v24, v25
v_mfma_f32_16x16x32_bf16 a[8:11], v[212:215], a[192:195], a[8:11]
s_waitcnt lgkmcnt(5)
v_exp_f32 v20, v52
v_mfma_f32_16x16x32_bf16 a[8:11], v[228:231], a[196:199], a[8:11]
s_add_u32 m0, s24, 65536
v_add_f32 v9, v9, v26
v_add_f32 v9, v9, v27
v_mfma_f32_16x16x32_bf16 a[12:15], v[232:235], a[196:199], a[12:15]
buffer_load_dwordx4 v3, s[8:11], s19 offen offset:0 sc1 lds
v_exp_f32 v21, v53
v_mfma_f32_16x16x32_bf16 a[12:15], v[216:219], a[192:195], a[12:15]
ds_read_b128 a[228:231], v2 offset:28672
v_cvt_pk_bf16_f32 v177, v26, v27
v_mfma_f32_16x16x32_bf16 a[16:19], v[204:207], a[200:203], a[16:19]
v_exp_f32 v22, v54
v_mfma_f32_16x16x32_bf16 a[16:19], v[220:223], a[204:207], a[16:19]
v_add_f32 v10, v20, v21
v_add_f32 v17, v17, v13
v_mfma_f32_16x16x32_bf16 a[20:23], v[224:227], a[204:207], a[20:23]
v_exp_f32 v23, v55
v_mfma_f32_16x16x32_bf16 a[20:23], v[208:211], a[200:203], a[20:23]
ds_read_b128 a[232:235], v2 offset:21504
v_cvt_pk_bf16_f32 v180, v20, v21
v_mfma_f32_16x16x32_bf16 a[24:27], v[212:215], a[200:203], a[24:27]
s_waitcnt lgkmcnt(5)
v_exp_f32 v24, v56
v_mfma_f32_16x16x32_bf16 a[24:27], v[228:231], a[204:207], a[24:27]
v_add_f32 v10, v10, v22
v_add_f32 v10, v10, v23
v_mfma_f32_16x16x32_bf16 a[28:31], v[232:235], a[204:207], a[28:31]
buffer_load_dwordx4 v3, s[8:11], s19 offen offset:1024 sc1 lds
v_exp_f32 v25, v57
v_mfma_f32_16x16x32_bf16 a[28:31], v[216:219], a[200:203], a[28:31]
ds_read_b128 a[236:239], v2 offset:29696
v_cvt_pk_bf16_f32 v181, v22, v23
v_mfma_f32_16x16x32_bf16 a[32:35], v[204:207], a[208:211], a[32:35]
v_exp_f32 v26, v58
v_mfma_f32_16x16x32_bf16 a[32:35], v[220:223], a[212:215], a[32:35]
v_add_f32 v11, v24, v25
v_add_f32 v18, v18, v14
v_mfma_f32_16x16x32_bf16 a[36:39], v[224:227], a[212:215], a[36:39]
v_exp_f32 v27, v59
v_mfma_f32_16x16x32_bf16 a[36:39], v[208:211], a[208:211], a[36:39]
ds_read_b128 a[240:243], v2 offset:22528
v_cvt_pk_bf16_f32 v184, v24, v25
v_mfma_f32_16x16x32_bf16 a[40:43], v[212:215], a[208:211], a[40:43]
s_waitcnt lgkmcnt(5)
v_exp_f32 v20, v60
v_mfma_f32_16x16x32_bf16 a[40:43], v[228:231], a[212:215], a[40:43]
v_add_f32 v11, v11, v26
v_add_f32 v11, v11, v27
v_mfma_f32_16x16x32_bf16 a[44:47], v[232:235], a[212:215], a[44:47]
buffer_load_dwordx4 v3, s[8:11], s19 offen offset:2048 sc1 lds
v_exp_f32 v21, v61
v_mfma_f32_16x16x32_bf16 a[44:47], v[216:219], a[208:211], a[44:47]
ds_read_b128 a[244:247], v2 offset:30720
v_cvt_pk_bf16_f32 v185, v26, v27
v_mfma_f32_16x16x32_bf16 a[48:51], v[204:207], a[216:219], a[48:51]
v_exp_f32 v22, v62
v_mfma_f32_16x16x32_bf16 a[48:51], v[220:223], a[220:223], a[48:51]
v_add_f32 v8, v8, v20
v_add_f32 v8, v8, v21
v_mfma_f32_16x16x32_bf16 a[52:55], v[224:227], a[220:223], a[52:55]
v_exp_f32 v23, v63
v_mfma_f32_16x16x32_bf16 a[52:55], v[208:211], a[216:219], a[52:55]
ds_read_b128 a[248:251], v2 offset:23552
v_cvt_pk_bf16_f32 v174, v20, v21
v_mfma_f32_16x16x32_bf16 a[56:59], v[212:215], a[216:219], a[56:59]
s_waitcnt lgkmcnt(5)
v_exp_f32 v24, v64
v_mfma_f32_16x16x32_bf16 a[56:59], v[228:231], a[220:223], a[56:59]
v_add_f32 v8, v8, v22
v_add_f32 v8, v8, v23
v_mfma_f32_16x16x32_bf16 a[60:63], v[232:235], a[220:223], a[60:63]
buffer_load_dwordx4 v3, s[8:11], s19 offen offset:3072 sc1 lds
v_exp_f32 v25, v65
v_mfma_f32_16x16x32_bf16 a[60:63], v[216:219], a[216:219], a[60:63]
ds_read_b128 a[252:255], v2 offset:31744
v_cvt_pk_bf16_f32 v175, v22, v23
v_mfma_f32_16x16x32_bf16 a[64:67], v[204:207], a[224:227], a[64:67]
s_add_u32 s19, s19, 32768
v_exp_f32 v26, v66
v_mfma_f32_16x16x32_bf16 a[64:67], v[220:223], a[228:231], a[64:67]
v_add_f32 v9, v9, v24
v_add_f32 v9, v9, v25
v_mfma_f32_16x16x32_bf16 a[68:71], v[224:227], a[228:231], a[68:71]
v_exp_f32 v27, v67
v_mfma_f32_16x16x32_bf16 a[68:71], v[208:211], a[224:227], a[68:71]
ds_read_b128 a[192:195], v1 offset:16384
v_cvt_pk_bf16_f32 v178, v24, v25
v_mfma_f32_16x16x32_bf16 a[72:75], v[212:215], a[224:227], a[72:75]
s_waitcnt lgkmcnt(5)
v_exp_f32 v20, v68
v_mfma_f32_16x16x32_bf16 a[72:75], v[228:231], a[228:231], a[72:75]
s_add_u32 m0, s24, 16384
v_add_f32 v9, v9, v26
v_add_f32 v9, v9, v27
v_mfma_f32_16x16x32_bf16 a[76:79], v[232:235], a[228:231], a[76:79]
buffer_load_dwordx4 v3, s[8:11], s18 offen offset:0 sc1 lds
v_exp_f32 v21, v69
v_mfma_f32_16x16x32_bf16 a[76:79], v[216:219], a[224:227], a[76:79]
ds_read_b128 a[196:199], v1 offset:17408
v_cvt_pk_bf16_f32 v179, v26, v27
v_mfma_f32_16x16x32_bf16 a[80:83], v[204:207], a[232:235], a[80:83]
v_exp_f32 v22, v70
v_mfma_f32_16x16x32_bf16 a[80:83], v[220:223], a[236:239], a[80:83]
v_add_f32 v10, v10, v20
v_add_f32 v10, v10, v21
v_mfma_f32_16x16x32_bf16 a[84:87], v[224:227], a[236:239], a[84:87]
v_exp_f32 v23, v71
v_mfma_f32_16x16x32_bf16 a[84:87], v[208:211], a[232:235], a[84:87]
ds_read_b128 a[200:203], v1 offset:18432
v_cvt_pk_bf16_f32 v182, v20, v21
v_mfma_f32_16x16x32_bf16 a[88:91], v[212:215], a[232:235], a[88:91]
s_waitcnt lgkmcnt(5)
v_exp_f32 v24, v72
v_mfma_f32_16x16x32_bf16 a[88:91], v[228:231], a[236:239], a[88:91]
v_add_f32 v10, v10, v22
v_add_f32 v10, v10, v23
v_mfma_f32_16x16x32_bf16 a[92:95], v[232:235], a[236:239], a[92:95]
buffer_load_dwordx4 v3, s[8:11], s18 offen offset:1024 sc1 lds
v_exp_f32 v25, v73
v_mfma_f32_16x16x32_bf16 a[92:95], v[216:219], a[232:235], a[92:95]
ds_read_b128 a[204:207], v1 offset:19456
v_cvt_pk_bf16_f32 v183, v22, v23
v_mfma_f32_16x16x32_bf16 a[96:99], v[204:207], a[240:243], a[96:99]
v_exp_f32 v26, v74
v_mfma_f32_16x16x32_bf16 a[96:99], v[220:223], a[244:247], a[96:99]
v_add_f32 v11, v11, v24
v_add_f32 v11, v11, v25
v_xor_b32 v2, 0x8000, v2
v_mfma_f32_16x16x32_bf16 a[100:103], v[224:227], a[244:247], a[100:103]
v_exp_f32 v27, v75
v_mfma_f32_16x16x32_bf16 a[100:103], v[208:211], a[240:243], a[100:103]
ds_read_b128 a[208:211], v1 offset:20480
v_cvt_pk_bf16_f32 v186, v24, v25
v_mfma_f32_16x16x32_bf16 a[104:107], v[212:215], a[240:243], a[104:107]
s_waitcnt lgkmcnt(5)
v_exp_f32 v20, v76
v_mfma_f32_16x16x32_bf16 a[104:107], v[228:231], a[244:247], a[104:107]
v_add_f32 v11, v11, v26
v_add_f32 v11, v11, v27
v_mfma_f32_16x16x32_bf16 a[108:111], v[232:235], a[244:247], a[108:111]
buffer_load_dwordx4 v3, s[8:11], s18 offen offset:2048 sc1 lds
v_exp_f32 v21, v77
v_mfma_f32_16x16x32_bf16 a[108:111], v[216:219], a[240:243], a[108:111]
ds_read_b128 a[212:215], v1 offset:21504
v_cvt_pk_bf16_f32 v187, v26, v27
v_mfma_f32_16x16x32_bf16 a[112:115], v[204:207], a[248:251], a[112:115]
v_exp_f32 v22, v78
v_mfma_f32_16x16x32_bf16 a[112:115], v[220:223], a[252:255], a[112:115]
v_add_f32 v8, v8, v20
v_add_f32 v8, v8, v21
v_mfma_f32_16x16x32_bf16 a[116:119], v[224:227], a[252:255], a[116:119]
v_exp_f32 v23, v79
v_mfma_f32_16x16x32_bf16 a[116:119], v[208:211], a[248:251], a[116:119]
ds_read_b128 a[216:219], v1 offset:22528
v_cvt_pk_bf16_f32 v188, v20, v21
v_mfma_f32_16x16x32_bf16 a[120:123], v[212:215], a[248:251], a[120:123]
s_waitcnt lgkmcnt(3)
v_exp_f32 v24, v80
v_mfma_f32_16x16x32_bf16 a[120:123], v[228:231], a[252:255], a[120:123]
v_add_f32 v8, v8, v22
v_add_f32 v8, v8, v23
v_mfma_f32_16x16x32_bf16 a[124:127], v[232:235], a[252:255], a[124:127]
buffer_load_dwordx4 v3, s[8:11], s18 offen offset:3072 sc1 lds
v_exp_f32 v25, v81
v_mfma_f32_16x16x32_bf16 a[124:127], v[216:219], a[248:251], a[124:127]
ds_read_b128 a[220:223], v1 offset:23552
v_cvt_pk_bf16_f32 v189, v22, v23
v_mfma_f32_16x16x32_bf16 v[108:111], a[192:195], a[128:131], v[28:31]
s_add_u32 s18, s18, 32768
v_exp_f32 v26, v82
v_mfma_f32_16x16x32_bf16 v[108:111], a[196:199], a[132:135], v[108:111]
v_add_f32 v9, v9, v24
v_add_f32 v9, v9, v25
v_mfma_f32_16x16x32_bf16 v[108:111], a[200:203], a[136:139], v[108:111]
v_exp_f32 v27, v83
v_mfma_f32_16x16x32_bf16 v[108:111], a[204:207], a[140:143], v[108:111]
ds_read_b128 a[224:227], v1 offset:24576
v_cvt_pk_bf16_f32 v192, v24, v25
v_mfma_f32_16x16x32_bf16 v[112:115], a[204:207], a[156:159], v[32:35]
v_exp_f32 v20, v84
v_mfma_f32_16x16x32_bf16 v[112:115], a[200:203], a[152:155], v[112:115]
v_add_f32 v9, v9, v26
v_add_f32 v9, v9, v27
v_mfma_f32_16x16x32_bf16 v[112:115], a[196:199], a[148:151], v[112:115]
v_exp_f32 v21, v85
v_mfma_f32_16x16x32_bf16 v[112:115], a[192:195], a[144:147], v[112:115]
ds_read_b128 a[228:231], v1 offset:25600
v_cvt_pk_bf16_f32 v193, v26, v27
v_mfma_f32_16x16x32_bf16 v[116:119], a[192:195], a[160:163], v[36:39]
v_exp_f32 v22, v86
v_mfma_f32_16x16x32_bf16 v[116:119], a[196:199], a[164:167], v[116:119]
v_add_f32 v10, v10, v20
v_add_f32 v10, v10, v21
v_mfma_f32_16x16x32_bf16 v[116:119], a[200:203], a[168:171], v[116:119]
v_exp_f32 v23, v87
v_mfma_f32_16x16x32_bf16 v[116:119], a[204:207], a[172:175], v[116:119]
ds_read_b128 a[232:235], v1 offset:26624
v_cvt_pk_bf16_f32 v196, v20, v21
v_mfma_f32_16x16x32_bf16 v[120:123], a[204:207], a[188:191], v[40:43]
s_waitcnt lgkmcnt(3)
v_exp_f32 v24, v88
v_mfma_f32_16x16x32_bf16 v[120:123], a[200:203], a[184:187], v[120:123]
v_add_f32 v10, v10, v22
v_add_f32 v10, v10, v23
v_mfma_f32_16x16x32_bf16 v[120:123], a[196:199], a[180:183], v[120:123]
v_exp_f32 v25, v89
v_mfma_f32_16x16x32_bf16 v[120:123], a[192:195], a[176:179], v[120:123]
ds_read_b128 a[236:239], v1 offset:27648
v_cvt_pk_bf16_f32 v197, v22, v23
v_mfma_f32_16x16x32_bf16 v[124:127], a[208:211], a[128:131], v[28:31]
v_exp_f32 v26, v90
v_mfma_f32_16x16x32_bf16 v[124:127], a[212:215], a[132:135], v[124:127]
v_add_f32 v11, v11, v24
v_add_f32 v11, v11, v25
v_mfma_f32_16x16x32_bf16 v[124:127], a[216:219], a[136:139], v[124:127]
v_exp_f32 v27, v91
v_mfma_f32_16x16x32_bf16 v[124:127], a[220:223], a[140:143], v[124:127]
ds_read_b128 a[240:243], v1 offset:28672
v_cvt_pk_bf16_f32 v200, v24, v25
v_mfma_f32_16x16x32_bf16 v[128:131], a[220:223], a[156:159], v[32:35]
v_exp_f32 v20, v92
v_mfma_f32_16x16x32_bf16 v[128:131], a[216:219], a[152:155], v[128:131]
v_add_f32 v11, v11, v26
v_add_f32 v11, v11, v27
v_mfma_f32_16x16x32_bf16 v[128:131], a[212:215], a[148:151], v[128:131]
v_exp_f32 v21, v93
v_mfma_f32_16x16x32_bf16 v[128:131], a[208:211], a[144:147], v[128:131]
ds_read_b128 a[244:247], v1 offset:29696
v_cvt_pk_bf16_f32 v201, v26, v27
v_mfma_f32_16x16x32_bf16 v[132:135], a[208:211], a[160:163], v[36:39]
v_exp_f32 v22, v94
v_mfma_f32_16x16x32_bf16 v[132:135], a[212:215], a[164:167], v[132:135]
v_add_f32 v8, v8, v20
v_add_f32 v8, v8, v21
v_mfma_f32_16x16x32_bf16 v[132:135], a[216:219], a[168:171], v[132:135]
v_exp_f32 v23, v95
v_mfma_f32_16x16x32_bf16 v[132:135], a[220:223], a[172:175], v[132:135]
ds_read_b128 a[248:251], v1 offset:30720
v_cvt_pk_bf16_f32 v190, v20, v21
v_mfma_f32_16x16x32_bf16 v[136:139], a[220:223], a[188:191], v[40:43]
s_waitcnt lgkmcnt(3)
v_exp_f32 v24, v96
v_mfma_f32_16x16x32_bf16 v[136:139], a[216:219], a[184:187], v[136:139]
s_waitcnt vmcnt(8)
v_add_f32 v8, v8, v22
v_add_f32 v8, v8, v23
v_mfma_f32_16x16x32_bf16 v[136:139], a[212:215], a[180:183], v[136:139]
s_barrier
v_exp_f32 v25, v97
v_mfma_f32_16x16x32_bf16 v[136:139], a[208:211], a[176:179], v[136:139]
ds_read_b128 a[252:255], v1 offset:31744
v_cvt_pk_bf16_f32 v191, v22, v23
v_mfma_f32_16x16x32_bf16 v[140:143], a[224:227], a[128:131], v[28:31]
v_exp_f32 v26, v98
v_mfma_f32_16x16x32_bf16 v[140:143], a[228:231], a[132:135], v[140:143]
v_add_f32 v9, v9, v24
v_add_f32 v9, v9, v25
v_mfma_f32_16x16x32_bf16 v[140:143], a[232:235], a[136:139], v[140:143]
v_exp_f32 v27, v99
v_mfma_f32_16x16x32_bf16 v[140:143], a[236:239], a[140:143], v[140:143]
ds_read_b128 a[192:195], v2 offset:0
v_cvt_pk_bf16_f32 v194, v24, v25
v_mfma_f32_16x16x32_bf16 v[144:147], a[236:239], a[156:159], v[32:35]
v_exp_f32 v20, v100
v_mfma_f32_16x16x32_bf16 v[144:147], a[232:235], a[152:155], v[144:147]
v_add_f32 v9, v9, v26
v_add_f32 v9, v9, v27
v_mfma_f32_16x16x32_bf16 v[144:147], a[228:231], a[148:151], v[144:147]
v_exp_f32 v21, v101
v_mfma_f32_16x16x32_bf16 v[144:147], a[224:227], a[144:147], v[144:147]
ds_read_b128 a[196:199], v2 offset:8192
v_cvt_pk_bf16_f32 v195, v26, v27
v_mfma_f32_16x16x32_bf16 v[148:151], a[224:227], a[160:163], v[36:39]
v_exp_f32 v22, v102
v_mfma_f32_16x16x32_bf16 v[148:151], a[228:231], a[164:167], v[148:151]
v_add_f32 v10, v10, v20
v_add_f32 v10, v10, v21
v_mfma_f32_16x16x32_bf16 v[148:151], a[232:235], a[168:171], v[148:151]
v_exp_f32 v23, v103
v_mfma_f32_16x16x32_bf16 v[148:151], a[236:239], a[172:175], v[148:151]
ds_read_b128 a[200:203], v2 offset:1024
v_cvt_pk_bf16_f32 v198, v20, v21
v_mfma_f32_16x16x32_bf16 v[152:155], a[236:239], a[188:191], v[40:43]
s_waitcnt lgkmcnt(3)
v_exp_f32 v24, v104
v_mfma_f32_16x16x32_bf16 v[152:155], a[232:235], a[184:187], v[152:155]
v_add_f32 v10, v10, v22
v_add_f32 v10, v10, v23
v_xor_b32 v1, 0x8000, v1
v_mfma_f32_16x16x32_bf16 v[152:155], a[228:231], a[180:183], v[152:155]
v_exp_f32 v25, v105
v_mfma_f32_16x16x32_bf16 v[152:155], a[224:227], a[176:179], v[152:155]
ds_read_b128 a[204:207], v2 offset:9216
v_cvt_pk_bf16_f32 v199, v22, v23
v_mfma_f32_16x16x32_bf16 v[156:159], a[240:243], a[128:131], v[28:31]
v_exp_f32 v26, v106
v_mfma_f32_16x16x32_bf16 v[156:159], a[244:247], a[132:135], v[156:159]
v_add_f32 v11, v11, v24
v_add_f32 v11, v11, v25
v_mfma_f32_16x16x32_bf16 v[156:159], a[248:251], a[136:139], v[156:159]
s_xor_b32 s24, s24, 0x8000
v_exp_f32 v27, v107
v_mfma_f32_16x16x32_bf16 v[156:159], a[252:255], a[140:143], v[156:159]
ds_read_b128 a[208:211], v2 offset:2048
v_cvt_pk_bf16_f32 v202, v24, v25
v_mfma_f32_16x16x32_bf16 v[160:163], a[252:255], a[156:159], v[32:35]
v_exp_f32 v20, v108
v_mfma_f32_16x16x32_bf16 v[160:163], a[248:251], a[152:155], v[160:163]
v_add_f32 v11, v11, v26
v_add_f32 v11, v11, v27
v_mfma_f32_16x16x32_bf16 v[160:163], a[244:247], a[148:151], v[160:163]
s_xor_b32 s25, s25, 0x8000
v_exp_f32 v21, v109
v_mfma_f32_16x16x32_bf16 v[160:163], a[240:243], a[144:147], v[160:163]
ds_read_b128 a[212:215], v2 offset:10240
v_cvt_pk_bf16_f32 v203, v26, v27
v_mfma_f32_16x16x32_bf16 v[164:167], a[240:243], a[160:163], v[36:39]
v_exp_f32 v22, v110
v_mfma_f32_16x16x32_bf16 v[164:167], a[244:247], a[164:167], v[164:167]
v_add_f32 v12, v20, v21
v_add_f32 v19, v19, v15
v_max3_f32 v7, v8, v9, v10
v_mfma_f32_16x16x32_bf16 v[164:167], a[248:251], a[168:171], v[164:167]
s_sub_u32 s20, s20, 1
v_exp_f32 v23, v111
v_max_f32 v7, v7, v11
v_mfma_f32_16x16x32_bf16 v[164:167], a[252:255], a[172:175], v[164:167]
ds_read_b128 a[216:219], v2 offset:3072
v_cvt_pk_bf16_f32 v204, v20, v21
v_cmp_nge_f32 vcc, s21, v7
v_mfma_f32_16x16x32_bf16 v[168:171], a[252:255], a[188:191], v[40:43]
s_waitcnt lgkmcnt(5)
v_exp_f32 v24, v112
v_mfma_f32_16x16x32_bf16 v[168:171], a[248:251], a[184:187], v[168:171]
v_add_f32 v12, v12, v22
v_add_f32 v12, v12, v23
v_mfma_f32_16x16x32_bf16 v[168:171], a[244:247], a[180:183], v[168:171]
v_exp_f32 v25, v113
v_mfma_f32_16x16x32_bf16 v[168:171], a[240:243], a[176:179], v[168:171]
ds_read_b128 a[220:223], v2 offset:11264
v_cvt_pk_bf16_f32 v205, v22, v23
s_cbranch_vccnz Ltr_l2
Lbk_l2:
s_cmp_eq_u32 s20, 14
s_cbranch_scc1 LB_slow
s_cmp_lg_u32 s20, 0
s_cbranch_scc1 Lloop
v_mfma_f32_16x16x32_bf16 a[0:3], v[172:175], a[192:195], a[0:3]
v_exp_f32 v26, v114
v_add_f32 v13, v24, v25
v_add_f32 v16, v16, v8
v_mfma_f32_16x16x32_bf16 a[0:3], v[188:191], a[196:199], a[0:3]
v_exp_f32 v27, v115
v_cvt_pk_bf16_f32 v208, v24, v25
v_add_f32 v19, v19, v11
v_mfma_f32_16x16x32_bf16 a[4:7], v[192:195], a[196:199], a[4:7]
v_exp_f32 v20, v116
v_add_f32 v13, v13, v26
v_add_f32 v13, v13, v27
v_mfma_f32_16x16x32_bf16 a[4:7], v[176:179], a[192:195], a[4:7]
ds_read_b128 a[224:227], v2 offset:4096
v_exp_f32 v21, v117
v_cvt_pk_bf16_f32 v209, v26, v27
v_mfma_f32_16x16x32_bf16 a[8:11], v[180:183], a[192:195], a[8:11]
s_waitcnt lgkmcnt(5)
v_exp_f32 v22, v118
v_add_f32 v14, v20, v21
v_add_f32 v17, v17, v9
v_mfma_f32_16x16x32_bf16 a[8:11], v[196:199], a[196:199], a[8:11]
v_exp_f32 v23, v119
v_cvt_pk_bf16_f32 v212, v20, v21
v_mfma_f32_16x16x32_bf16 a[12:15], v[200:203], a[196:199], a[12:15]
v_exp_f32 v24, v120
v_add_f32 v14, v14, v22
v_add_f32 v14, v14, v23
v_mfma_f32_16x16x32_bf16 a[12:15], v[184:187], a[192:195], a[12:15]
ds_read_b128 a[228:231], v2 offset:12288
ds_read_b128 a[192:195], v2 offset:16384
v_exp_f32 v25, v121
v_mfma_f32_16x16x32_bf16 a[16:19], v[172:175], a[200:203], a[16:19]
v_cvt_pk_bf16_f32 v213, v22, v23
v_exp_f32 v26, v122
v_mfma_f32_16x16x32_bf16 a[16:19], v[188:191], a[204:207], a[16:19]
ds_read_b128 a[196:199], v2 offset:24576
v_add_f32 v15, v24, v25
v_add_f32 v18, v18, v10
v_exp_f32 v27, v123
v_mfma_f32_16x16x32_bf16 a[20:23], v[192:195], a[204:207], a[20:23]
v_cvt_pk_bf16_f32 v216, v24, v25
v_exp_f32 v20, v124
v_mfma_f32_16x16x32_bf16 a[20:23], v[176:179], a[200:203], a[20:23]
ds_read_b128 a[232:235], v2 offset:5120
v_add_f32 v15, v15, v26
v_add_f32 v15, v15, v27
v_exp_f32 v21, v125
v_mfma_f32_16x16x32_bf16 a[24:27], v[180:183], a[200:203], a[24:27]
s_waitcnt lgkmcnt(7)
v_cvt_pk_bf16_f32 v217, v26, v27
v_exp_f32 v22, v126
v_mfma_f32_16x16x32_bf16 a[24:27], v[196:199], a[204:207], a[24:27]
v_add_f32 v12, v12, v20
v_add_f32 v12, v12, v21
v_exp_f32 v23, v127
v_mfma_f32_16x16x32_bf16 a[28:31], v[200:203], a[204:207], a[28:31]
v_cvt_pk_bf16_f32 v206, v20, v21
v_exp_f32 v24, v128
v_mfma_f32_16x16x32_bf16 a[28:31], v[184:187], a[200:203], a[28:31]
ds_read_b128 a[236:239], v2 offset:13312
ds_read_b128 a[200:203], v2 offset:17408
v_add_f32 v12, v12, v22
v_add_f32 v12, v12, v23
v_mfma_f32_16x16x32_bf16 a[32:35], v[172:175], a[208:211], a[32:35]
v_exp_f32 v25, v129
v_cvt_pk_bf16_f32 v207, v22, v23
v_mfma_f32_16x16x32_bf16 a[32:35], v[188:191], a[212:215], a[32:35]
ds_read_b128 a[204:207], v2 offset:25600
v_exp_f32 v26, v130
v_add_f32 v13, v13, v24
v_add_f32 v13, v13, v25
v_mfma_f32_16x16x32_bf16 a[36:39], v[192:195], a[212:215], a[36:39]
v_exp_f32 v27, v131
v_cvt_pk_bf16_f32 v210, v24, v25
v_mfma_f32_16x16x32_bf16 a[36:39], v[176:179], a[208:211], a[36:39]
ds_read_b128 a[240:243], v2 offset:6144
v_exp_f32 v20, v132
v_add_f32 v13, v13, v26
v_add_f32 v13, v13, v27
v_mfma_f32_16x16x32_bf16 a[40:43], v[180:183], a[208:211], a[40:43]
s_waitcnt lgkmcnt(9)
v_exp_f32 v21, v133
v_cvt_pk_bf16_f32 v211, v26, v27
v_mfma_f32_16x16x32_bf16 a[40:43], v[196:199], a[212:215], a[40:43]
v_exp_f32 v22, v134
v_add_f32 v14, v14, v20
v_add_f32 v14, v14, v21
v_mfma_f32_16x16x32_bf16 a[44:47], v[200:203], a[212:215], a[44:47]
v_exp_f32 v23, v135
v_cvt_pk_bf16_f32 v214, v20, v21
v_mfma_f32_16x16x32_bf16 a[44:47], v[184:187], a[208:211], a[44:47]
ds_read_b128 a[244:247], v2 offset:14336
ds_read_b128 a[208:211], v2 offset:18432
v_exp_f32 v24, v136
v_mfma_f32_16x16x32_bf16 a[48:51], v[172:175], a[216:219], a[48:51]
v_add_f32 v14, v14, v22
v_add_f32 v14, v14, v23
v_exp_f32 v25, v137
v_mfma_f32_16x16x32_bf16 a[48:51], v[188:191], a[220:223], a[48:51]
ds_read_b128 a[212:215], v2 offset:26624
v_cvt_pk_bf16_f32 v215, v22, v23
v_exp_f32 v26, v138
v_mfma_f32_16x16x32_bf16 a[52:55], v[192:195], a[220:223], a[52:55]
v_add_f32 v15, v15, v24
v_add_f32 v15, v15, v25
v_exp_f32 v27, v139
v_mfma_f32_16x16x32_bf16 a[52:55], v[176:179], a[216:219], a[52:55]
ds_read_b128 a[248:251], v2 offset:7168
v_cvt_pk_bf16_f32 v218, v24, v25
v_exp_f32 v20, v140
v_mfma_f32_16x16x32_bf16 a[56:59], v[180:183], a[216:219], a[56:59]
s_waitcnt lgkmcnt(11)
v_add_f32 v15, v15, v26
v_add_f32 v15, v15, v27
v_exp_f32 v21, v141
v_mfma_f32_16x16x32_bf16 a[56:59], v[196:199], a[220:223], a[56:59]
v_cvt_pk_bf16_f32 v219, v26, v27
v_exp_f32 v22, v142
v_mfma_f32_16x16x32_bf16 a[60:63], v[200:203], a[220:223], a[60:63]
v_add_f32 v12, v12, v20
v_add_f32 v12, v12, v21
v_exp_f32 v23, v143
v_mfma_f32_16x16x32_bf16 a[60:63], v[184:187], a[216:219], a[60:63]
ds_read_b128 a[252:255], v2 offset:15360
ds_read_b128 a[216:219], v2 offset:19456
v_cvt_pk_bf16_f32 v220, v20, v21
v_mfma_f32_16x16x32_bf16 a[64:67], v[172:175], a[224:227], a[64:67]
v_exp_f32 v24, v144
v_add_f32 v12, v12, v22
v_add_f32 v12, v12, v23
v_mfma_f32_16x16x32_bf16 a[64:67], v[188:191], a[228:231], a[64:67]
ds_read_b128 a[220:223], v2 offset:27648
v_exp_f32 v25, v145
v_cvt_pk_bf16_f32 v221, v22, v23
v_mfma_f32_16x16x32_bf16 a[68:71], v[192:195], a[228:231], a[68:71]
v_exp_f32 v26, v146
v_add_f32 v13, v13, v24
v_add_f32 v13, v13, v25
v_mfma_f32_16x16x32_bf16 a[68:71], v[176:179], a[224:227], a[68:71]
v_exp_f32 v27, v147
v_cvt_pk_bf16_f32 v224, v24, v25
v_mfma_f32_16x16x32_bf16 a[72:75], v[180:183], a[224:227], a[72:75]
s_waitcnt lgkmcnt(10)
v_exp_f32 v20, v148
v_add_f32 v13, v13, v26
v_add_f32 v13, v13, v27
v_mfma_f32_16x16x32_bf16 a[72:75], v[196:199], a[228:231], a[72:75]
v_exp_f32 v21, v149
v_cvt_pk_bf16_f32 v225, v26, v27
v_mfma_f32_16x16x32_bf16 a[76:79], v[200:203], a[228:231], a[76:79]
v_exp_f32 v22, v150
v_add_f32 v14, v14, v20
v_add_f32 v14, v14, v21
v_mfma_f32_16x16x32_bf16 a[76:79], v[184:187], a[224:227], a[76:79]
ds_read_b128 a[224:227], v2 offset:20480
v_exp_f32 v23, v151
v_mfma_f32_16x16x32_bf16 a[80:83], v[172:175], a[232:235], a[80:83]
v_cvt_pk_bf16_f32 v228, v20, v21
v_exp_f32 v24, v152
v_mfma_f32_16x16x32_bf16 a[80:83], v[188:191], a[236:239], a[80:83]
ds_read_b128 a[228:231], v2 offset:28672
v_add_f32 v14, v14, v22
v_add_f32 v14, v14, v23
v_exp_f32 v25, v153
v_mfma_f32_16x16x32_bf16 a[84:87], v[192:195], a[236:239], a[84:87]
v_cvt_pk_bf16_f32 v229, v22, v23
v_exp_f32 v26, v154
v_mfma_f32_16x16x32_bf16 a[84:87], v[176:179], a[232:235], a[84:87]
v_add_f32 v15, v15, v24
v_add_f32 v15, v15, v25
v_exp_f32 v27, v155
v_mfma_f32_16x16x32_bf16 a[88:91], v[180:183], a[232:235], a[88:91]
s_waitcnt lgkmcnt(8)
v_cvt_pk_bf16_f32 v232, v24, v25
v_exp_f32 v20, v156
v_mfma_f32_16x16x32_bf16 a[88:91], v[196:199], a[236:239], a[88:91]
v_add_f32 v15, v15, v26
v_add_f32 v15, v15, v27
v_exp_f32 v21, v157
v_mfma_f32_16x16x32_bf16 a[92:95], v[200:203], a[236:239], a[92:95]
v_cvt_pk_bf16_f32 v233, v26, v27
v_exp_f32 v22, v158
v_mfma_f32_16x16x32_bf16 a[92:95], v[184:187], a[232:235], a[92:95]
ds_read_b128 a[232:235], v2 offset:21504
v_add_f32 v12, v12, v20
v_add_f32 v12, v12, v21
v_mfma_f32_16x16x32_bf16 a[96:99], v[172:175], a[240:243], a[96:99]
v_exp_f32 v23, v159
v_cvt_pk_bf16_f32 v222, v20, v21
v_mfma_f32_16x16x32_bf16 a[96:99], v[188:191], a[244:247], a[96:99]
ds_read_b128 a[236:239], v2 offset:29696
v_exp_f32 v24, v160
v_add_f32 v12, v12, v22
v_add_f32 v12, v12, v23
v_mfma_f32_16x16x32_bf16 a[100:103], v[192:195], a[244:247], a[100:103]
v_exp_f32 v25, v161
v_cvt_pk_bf16_f32 v223, v22, v23
v_mfma_f32_16x16x32_bf16 a[100:103], v[176:179], a[240:243], a[100:103]
v_exp_f32 v26, v162
v_add_f32 v13, v13, v24
v_add_f32 v13, v13, v25
v_mfma_f32_16x16x32_bf16 a[104:107], v[180:183], a[240:243], a[104:107]
s_waitcnt lgkmcnt(6)
v_exp_f32 v27, v163
v_cvt_pk_bf16_f32 v226, v24, v25
v_mfma_f32_16x16x32_bf16 a[104:107], v[196:199], a[244:247], a[104:107]
v_exp_f32 v20, v164
v_add_f32 v13, v13, v26
v_add_f32 v13, v13, v27
v_mfma_f32_16x16x32_bf16 a[108:111], v[200:203], a[244:247], a[108:111]
v_exp_f32 v21, v165
v_cvt_pk_bf16_f32 v227, v26, v27
v_mfma_f32_16x16x32_bf16 a[108:111], v[184:187], a[240:243], a[108:111]
ds_read_b128 a[240:243], v2 offset:22528
v_exp_f32 v22, v166
v_mfma_f32_16x16x32_bf16 a[112:115], v[172:175], a[248:251], a[112:115]
v_add_f32 v14, v14, v20
v_add_f32 v14, v14, v21
v_exp_f32 v23, v167
v_mfma_f32_16x16x32_bf16 a[112:115], v[188:191], a[252:255], a[112:115]
ds_read_b128 a[244:247], v2 offset:30720
v_cvt_pk_bf16_f32 v230, v20, v21
v_exp_f32 v24, v168
v_mfma_f32_16x16x32_bf16 a[116:119], v[192:195], a[252:255], a[116:119]
v_add_f32 v14, v14, v22
v_add_f32 v14, v14, v23
v_exp_f32 v25, v169
v_mfma_f32_16x16x32_bf16 a[116:119], v[176:179], a[248:251], a[116:119]
v_cvt_pk_bf16_f32 v231, v22, v23
v_exp_f32 v26, v170
v_mfma_f32_16x16x32_bf16 a[120:123], v[180:183], a[248:251], a[120:123]
v_add_f32 v15, v15, v24
v_add_f32 v15, v15, v25
v_exp_f32 v27, v171
v_mfma_f32_16x16x32_bf16 a[120:123], v[196:199], a[252:255], a[120:123]
v_cvt_pk_bf16_f32 v234, v24, v25
v_mfma_f32_16x16x32_bf16 a[124:127], v[200:203], a[252:255], a[124:127]
v_add_f32 v15, v15, v26
v_add_f32 v15, v15, v27
v_mfma_f32_16x16x32_bf16 a[124:127], v[184:187], a[248:251], a[124:127]
ds_read_b128 a[248:251], v2 offset:23552
ds_read_b128 a[252:255], v2 offset:31744
v_cvt_pk_bf16_f32 v235, v26, v27
v_max3_f32 v7, v12, v13, v14
v_max_f32 v7, v7, v15
v_cmp_nge_f32 vcc, s21, v7
s_cbranch_vccnz Ltr_t31
Lbk_t31:
s_add_u32 s56, s30, 0
s_add_u32 s57, s30, 4096
s_add_u32 s58, s30, 8192
s_add_u32 s59, s30, 12288
s_waitcnt lgkmcnt(8)
v_mfma_f32_16x16x32_bf16 a[0:3], v[204:207], a[192:195], a[0:3]
v_add_f32 v16, v16, v12
v_add_f32 v17, v17, v13
v_add_f32 v18, v18, v14
v_add_f32 v19, v19, v15
v_mfma_f32_16x16x32_bf16 a[0:3], v[220:223], a[196:199], a[0:3]
v_mov_b32 v20, v16
v_mov_b32 v21, v17
v_mov_b32 v22, v18
v_mov_b32 v23, v19
v_mfma_f32_16x16x32_bf16 a[16:19], v[220:223], a[204:207], a[16:19]
v_permlane32_swap_b32 v16, v20
v_permlane32_swap_b32 v17, v21
v_permlane32_swap_b32 v18, v22
v_mfma_f32_16x16x32_bf16 a[16:19], v[204:207], a[200:203], a[16:19]
v_permlane32_swap_b32 v19, v23
v_add_f32 v16, v16, v20
v_add_f32 v17, v17, v21
v_add_f32 v18, v18, v22
v_mfma_f32_16x16x32_bf16 a[32:35], v[204:207], a[208:211], a[32:35]
v_add_f32 v19, v19, v23
v_mov_b32 v20, v16
v_mov_b32 v21, v17
v_mfma_f32_16x16x32_bf16 a[32:35], v[220:223], a[212:215], a[32:35]
v_mov_b32 v22, v18
v_mov_b32 v23, v19
v_permlane16_swap_b32 v16, v20
v_permlane16_swap_b32 v17, v21
v_mfma_f32_16x16x32_bf16 a[48:51], v[220:223], a[220:223], a[48:51]
s_waitcnt lgkmcnt(4)
v_permlane16_swap_b32 v18, v22
v_permlane16_swap_b32 v19, v23
v_add_f32 v16, v16, v20
v_mfma_f32_16x16x32_bf16 a[48:51], v[204:207], a[216:219], a[48:51]
v_add_f32 v17, v17, v21
v_add_f32 v18, v18, v22
v_add_f32 v19, v19, v23
v_rcp_f32 v16, v16
v_mfma_f32_16x16x32_bf16 a[64:67], v[204:207], a[224:227], a[64:67]
v_rcp_f32 v17, v17
v_rcp_f32 v18, v18
v_rcp_f32 v19, v19
v_mfma_f32_16x16x32_bf16 a[64:67], v[220:223], a[228:231], a[64:67]
s_waitcnt lgkmcnt(0)
v_mfma_f32_16x16x32_bf16 a[80:83], v[220:223], a[236:239], a[80:83]
ds_bpermute_b32 v140, v4, v16 offset:0
ds_bpermute_b32 v141, v4, v16 offset:4
ds_bpermute_b32 v142, v4, v16 offset:8
ds_bpermute_b32 v143, v4, v16 offset:12
v_mfma_f32_16x16x32_bf16 a[80:83], v[204:207], a[232:235], a[80:83]
ds_bpermute_b32 v144, v4, v17 offset:0
ds_bpermute_b32 v145, v4, v17 offset:4
ds_bpermute_b32 v146, v4, v17 offset:8
ds_bpermute_b32 v147, v4, v17 offset:12
v_mfma_f32_16x16x32_bf16 a[96:99], v[204:207], a[240:243], a[96:99]
ds_bpermute_b32 v148, v4, v18 offset:0
ds_bpermute_b32 v149, v4, v18 offset:4
ds_bpermute_b32 v150, v4, v18 offset:8
ds_bpermute_b32 v151, v4, v18 offset:12
v_mfma_f32_16x16x32_bf16 a[96:99], v[220:223], a[244:247], a[96:99]
ds_bpermute_b32 v152, v4, v19 offset:0
ds_bpermute_b32 v153, v4, v19 offset:4
ds_bpermute_b32 v154, v4, v19 offset:8
ds_bpermute_b32 v155, v4, v19 offset:12
v_mfma_f32_16x16x32_bf16 a[112:115], v[220:223], a[252:255], a[112:115]
v_mfma_f32_16x16x32_bf16 a[112:115], v[204:207], a[248:251], a[112:115]
v_mfma_f32_16x16x32_bf16 a[4:7], v[208:211], a[192:195], a[4:7]
v_mfma_f32_16x16x32_bf16 a[4:7], v[224:227], a[196:199], a[4:7]
s_waitcnt lgkmcnt(0)
v_mfma_f32_16x16x32_bf16 a[20:23], v[224:227], a[204:207], a[20:23]
v_accvgpr_read_b32 v44, a0
v_accvgpr_read_b32 v45, a16
v_accvgpr_read_b32 v46, a32
v_accvgpr_read_b32 v47, a48
v_accvgpr_read_b32 v48, a64
v_accvgpr_read_b32 v49, a80
v_mfma_f32_16x16x32_bf16 a[20:23], v[208:211], a[200:203], a[20:23]
v_accvgpr_read_b32 v50, a96
v_accvgpr_read_b32 v51, a112
v_mul_f32 v44, v44, v140
v_mul_f32 v45, v45, v140
v_mul_f32 v46, v46, v140
v_mul_f32 v47, v47, v140
v_mfma_f32_16x16x32_bf16 a[36:39], v[208:211], a[208:211], a[36:39]
v_mul_f32 v48, v48, v140
v_mul_f32 v49, v49, v140
v_mul_f32 v50, v50, v140
v_mul_f32 v51, v51, v140
v_cvt_pk_bf16_f32 v52, v44, v45
v_cvt_pk_bf16_f32 v53, v46, v47
v_mfma_f32_16x16x32_bf16 a[36:39], v[224:227], a[212:215], a[36:39]
v_cvt_pk_bf16_f32 v54, v48, v49
v_cvt_pk_bf16_f32 v55, v50, v51
buffer_store_dwordx4 v[52:55], v5, s[12:15], s56 offen offset:0 sc1
v_accvgpr_read_b32 v56, a1
v_accvgpr_read_b32 v57, a17
v_accvgpr_read_b32 v58, a33
v_mfma_f32_16x16x32_bf16 a[52:55], v[224:227], a[220:223], a[52:55]
v_accvgpr_read_b32 v59, a49
v_accvgpr_read_b32 v60, a65
v_accvgpr_read_b32 v61, a81
v_accvgpr_read_b32 v62, a97
v_accvgpr_read_b32 v63, a113
v_mul_f32 v56, v56, v141
v_mfma_f32_16x16x32_bf16 a[52:55], v[208:211], a[216:219], a[52:55]
v_mul_f32 v57, v57, v141
v_mul_f32 v58, v58, v141
v_mul_f32 v59, v59, v141
v_mul_f32 v60, v60, v141
v_mul_f32 v61, v61, v141
v_mul_f32 v62, v62, v141
v_mfma_f32_16x16x32_bf16 a[68:71], v[208:211], a[224:227], a[68:71]
v_mul_f32 v63, v63, v141
v_cvt_pk_bf16_f32 v64, v56, v57
v_cvt_pk_bf16_f32 v65, v58, v59
v_cvt_pk_bf16_f32 v66, v60, v61
v_cvt_pk_bf16_f32 v67, v62, v63
buffer_store_dwordx4 v[64:67], v5, s[12:15], s56 offen offset:256 sc1
v_mfma_f32_16x16x32_bf16 a[68:71], v[224:227], a[228:231], a[68:71]
v_accvgpr_read_b32 v68, a2
v_accvgpr_read_b32 v69, a18
v_accvgpr_read_b32 v70, a34
v_accvgpr_read_b32 v71, a50
v_accvgpr_read_b32 v72, a66
v_accvgpr_read_b32 v73, a82
v_mfma_f32_16x16x32_bf16 a[84:87], v[224:227], a[236:239], a[84:87]
v_accvgpr_read_b32 v74, a98
v_accvgpr_read_b32 v75, a114
v_mul_f32 v68, v68, v142
v_mul_f32 v69, v69, v142
v_mul_f32 v70, v70, v142
v_mul_f32 v71, v71, v142
v_mfma_f32_16x16x32_bf16 a[84:87], v[208:211], a[232:235], a[84:87]
v_mul_f32 v72, v72, v142
v_mul_f32 v73, v73, v142
v_mul_f32 v74, v74, v142
v_mul_f32 v75, v75, v142
v_cvt_pk_bf16_f32 v76, v68, v69
v_cvt_pk_bf16_f32 v77, v70, v71
v_mfma_f32_16x16x32_bf16 a[100:103], v[208:211], a[240:243], a[100:103]
v_cvt_pk_bf16_f32 v78, v72, v73
v_cvt_pk_bf16_f32 v79, v74, v75
buffer_store_dwordx4 v[76:79], v5, s[12:15], s56 offen offset:512 sc1
v_accvgpr_read_b32 v80, a3
v_accvgpr_read_b32 v81, a19
v_accvgpr_read_b32 v82, a35
v_mfma_f32_16x16x32_bf16 a[100:103], v[224:227], a[244:247], a[100:103]
v_accvgpr_read_b32 v83, a51
v_accvgpr_read_b32 v84, a67
v_accvgpr_read_b32 v85, a83
v_accvgpr_read_b32 v86, a99
v_accvgpr_read_b32 v87, a115
v_mul_f32 v80, v80, v143
v_mfma_f32_16x16x32_bf16 a[116:119], v[224:227], a[252:255], a[116:119]
v_mul_f32 v81, v81, v143
v_mul_f32 v82, v82, v143
v_mul_f32 v83, v83, v143
v_mul_f32 v84, v84, v143
v_mul_f32 v85, v85, v143
v_mul_f32 v86, v86, v143
v_mfma_f32_16x16x32_bf16 a[116:119], v[208:211], a[248:251], a[116:119]
v_mul_f32 v87, v87, v143
v_cvt_pk_bf16_f32 v88, v80, v81
v_cvt_pk_bf16_f32 v89, v82, v83
v_cvt_pk_bf16_f32 v90, v84, v85
v_cvt_pk_bf16_f32 v91, v86, v87
buffer_store_dwordx4 v[88:91], v5, s[12:15], s56 offen offset:768 sc1
v_mfma_f32_16x16x32_bf16 a[8:11], v[212:215], a[192:195], a[8:11]
v_accvgpr_read_b32 v92, a4
v_accvgpr_read_b32 v93, a20
v_accvgpr_read_b32 v94, a36
v_accvgpr_read_b32 v95, a52
v_accvgpr_read_b32 v96, a68
v_accvgpr_read_b32 v97, a84
v_mfma_f32_16x16x32_bf16 a[8:11], v[228:231], a[196:199], a[8:11]
v_accvgpr_read_b32 v98, a100
v_accvgpr_read_b32 v99, a116
v_mul_f32 v92, v92, v144
v_mul_f32 v93, v93, v144
v_mul_f32 v94, v94, v144
v_mfma_f32_16x16x32_bf16 a[24:27], v[228:231], a[204:207], a[24:27]
v_mul_f32 v95, v95, v144
v_mul_f32 v96, v96, v144
v_mul_f32 v97, v97, v144
v_mul_f32 v98, v98, v144
v_mul_f32 v99, v99, v144
v_mfma_f32_16x16x32_bf16 a[24:27], v[212:215], a[200:203], a[24:27]
v_cvt_pk_bf16_f32 v100, v92, v93
v_cvt_pk_bf16_f32 v101, v94, v95
v_cvt_pk_bf16_f32 v102, v96, v97
v_cvt_pk_bf16_f32 v103, v98, v99
buffer_store_dwordx4 v[100:103], v5, s[12:15], s57 offen offset:0 sc1
v_mfma_f32_16x16x32_bf16 a[40:43], v[212:215], a[208:211], a[40:43]
v_accvgpr_read_b32 v104, a5
v_accvgpr_read_b32 v105, a21
v_accvgpr_read_b32 v106, a37
v_accvgpr_read_b32 v107, a53
v_accvgpr_read_b32 v108, a69
v_accvgpr_read_b32 v109, a85
v_mfma_f32_16x16x32_bf16 a[40:43], v[228:231], a[212:215], a[40:43]
v_accvgpr_read_b32 v110, a101
v_accvgpr_read_b32 v111, a117
v_mul_f32 v104, v104, v145
v_mul_f32 v105, v105, v145
v_mul_f32 v106, v106, v145
v_mfma_f32_16x16x32_bf16 a[56:59], v[228:231], a[220:223], a[56:59]
v_mul_f32 v107, v107, v145
v_mul_f32 v108, v108, v145
v_mul_f32 v109, v109, v145
v_mul_f32 v110, v110, v145
v_mul_f32 v111, v111, v145
v_mfma_f32_16x16x32_bf16 a[56:59], v[212:215], a[216:219], a[56:59]
v_cvt_pk_bf16_f32 v112, v104, v105
v_cvt_pk_bf16_f32 v113, v106, v107
v_cvt_pk_bf16_f32 v114, v108, v109
v_cvt_pk_bf16_f32 v115, v110, v111
buffer_store_dwordx4 v[112:115], v5, s[12:15], s57 offen offset:256 sc1
v_mfma_f32_16x16x32_bf16 a[72:75], v[212:215], a[224:227], a[72:75]
v_accvgpr_read_b32 v116, a6
v_accvgpr_read_b32 v117, a22
v_accvgpr_read_b32 v118, a38
v_accvgpr_read_b32 v119, a54
v_accvgpr_read_b32 v120, a70
v_accvgpr_read_b32 v121, a86
v_mfma_f32_16x16x32_bf16 a[72:75], v[228:231], a[228:231], a[72:75]
v_accvgpr_read_b32 v122, a102
v_accvgpr_read_b32 v123, a118
v_mul_f32 v116, v116, v146
v_mul_f32 v117, v117, v146
v_mul_f32 v118, v118, v146
v_mfma_f32_16x16x32_bf16 a[88:91], v[228:231], a[236:239], a[88:91]
v_mul_f32 v119, v119, v146
v_mul_f32 v120, v120, v146
v_mul_f32 v121, v121, v146
v_mul_f32 v122, v122, v146
v_mul_f32 v123, v123, v146
v_mfma_f32_16x16x32_bf16 a[88:91], v[212:215], a[232:235], a[88:91]
v_cvt_pk_bf16_f32 v124, v116, v117
v_cvt_pk_bf16_f32 v125, v118, v119
v_cvt_pk_bf16_f32 v126, v120, v121
v_cvt_pk_bf16_f32 v127, v122, v123
buffer_store_dwordx4 v[124:127], v5, s[12:15], s57 offen offset:512 sc1
v_mfma_f32_16x16x32_bf16 a[104:107], v[212:215], a[240:243], a[104:107]
v_accvgpr_read_b32 v128, a7
v_accvgpr_read_b32 v129, a23
v_accvgpr_read_b32 v130, a39
v_accvgpr_read_b32 v131, a55
v_accvgpr_read_b32 v132, a71
v_accvgpr_read_b32 v133, a87
v_mfma_f32_16x16x32_bf16 a[104:107], v[228:231], a[244:247], a[104:107]
v_accvgpr_read_b32 v134, a103
v_accvgpr_read_b32 v135, a119
v_mul_f32 v128, v128, v147
v_mul_f32 v129, v129, v147
v_mul_f32 v130, v130, v147
v_mfma_f32_16x16x32_bf16 a[120:123], v[228:231], a[252:255], a[120:123]
v_mul_f32 v131, v131, v147
v_mul_f32 v132, v132, v147
v_mul_f32 v133, v133, v147
v_mul_f32 v134, v134, v147
v_mul_f32 v135, v135, v147
v_mfma_f32_16x16x32_bf16 a[120:123], v[212:215], a[248:251], a[120:123]
v_cvt_pk_bf16_f32 v136, v128, v129
v_cvt_pk_bf16_f32 v137, v130, v131
v_cvt_pk_bf16_f32 v138, v132, v133
v_cvt_pk_bf16_f32 v139, v134, v135
buffer_store_dwordx4 v[136:139], v5, s[12:15], s57 offen offset:768 sc1
v_mfma_f32_16x16x32_bf16 a[12:15], v[216:219], a[192:195], a[12:15]
v_accvgpr_read_b32 v44, a8
v_accvgpr_read_b32 v45, a24
v_accvgpr_read_b32 v46, a40
v_accvgpr_read_b32 v47, a56
v_accvgpr_read_b32 v48, a72
v_accvgpr_read_b32 v49, a88
v_mfma_f32_16x16x32_bf16 a[12:15], v[232:235], a[196:199], a[12:15]
v_accvgpr_read_b32 v50, a104
v_accvgpr_read_b32 v51, a120
v_mul_f32 v44, v44, v148
v_mul_f32 v45, v45, v148
v_mul_f32 v46, v46, v148
v_mfma_f32_16x16x32_bf16 a[28:31], v[232:235], a[204:207], a[28:31]
v_mul_f32 v47, v47, v148
v_mul_f32 v48, v48, v148
v_mul_f32 v49, v49, v148
v_mul_f32 v50, v50, v148
v_mul_f32 v51, v51, v148
v_mfma_f32_16x16x32_bf16 a[28:31], v[216:219], a[200:203], a[28:31]
v_cvt_pk_bf16_f32 v52, v44, v45
v_cvt_pk_bf16_f32 v53, v46, v47
v_cvt_pk_bf16_f32 v54, v48, v49
v_cvt_pk_bf16_f32 v55, v50, v51
buffer_store_dwordx4 v[52:55], v5, s[12:15], s58 offen offset:0 sc1
v_mfma_f32_16x16x32_bf16 a[44:47], v[216:219], a[208:211], a[44:47]
v_accvgpr_read_b32 v56, a9
v_accvgpr_read_b32 v57, a25
v_accvgpr_read_b32 v58, a41
v_accvgpr_read_b32 v59, a57
v_accvgpr_read_b32 v60, a73
v_accvgpr_read_b32 v61, a89
v_mfma_f32_16x16x32_bf16 a[44:47], v[232:235], a[212:215], a[44:47]
v_accvgpr_read_b32 v62, a105
v_accvgpr_read_b32 v63, a121
v_mul_f32 v56, v56, v149
v_mul_f32 v57, v57, v149
v_mul_f32 v58, v58, v149
v_mfma_f32_16x16x32_bf16 a[60:63], v[232:235], a[220:223], a[60:63]
v_mul_f32 v59, v59, v149
v_mul_f32 v60, v60, v149
v_mul_f32 v61, v61, v149
v_mul_f32 v62, v62, v149
v_mul_f32 v63, v63, v149
v_mfma_f32_16x16x32_bf16 a[60:63], v[216:219], a[216:219], a[60:63]
v_cvt_pk_bf16_f32 v64, v56, v57
v_cvt_pk_bf16_f32 v65, v58, v59
v_cvt_pk_bf16_f32 v66, v60, v61
v_cvt_pk_bf16_f32 v67, v62, v63
buffer_store_dwordx4 v[64:67], v5, s[12:15], s58 offen offset:256 sc1
v_mfma_f32_16x16x32_bf16 a[76:79], v[216:219], a[224:227], a[76:79]
v_accvgpr_read_b32 v68, a10
v_accvgpr_read_b32 v69, a26
v_accvgpr_read_b32 v70, a42
v_accvgpr_read_b32 v71, a58
v_accvgpr_read_b32 v72, a74
v_accvgpr_read_b32 v73, a90
v_mfma_f32_16x16x32_bf16 a[76:79], v[232:235], a[228:231], a[76:79]
v_accvgpr_read_b32 v74, a106
v_accvgpr_read_b32 v75, a122
v_mul_f32 v68, v68, v150
v_mul_f32 v69, v69, v150
v_mul_f32 v70, v70, v150
v_mfma_f32_16x16x32_bf16 a[92:95], v[232:235], a[236:239], a[92:95]
v_mul_f32 v71, v71, v150
v_mul_f32 v72, v72, v150
v_mul_f32 v73, v73, v150
v_mul_f32 v74, v74, v150
v_mul_f32 v75, v75, v150
v_mfma_f32_16x16x32_bf16 a[92:95], v[216:219], a[232:235], a[92:95]
v_cvt_pk_bf16_f32 v76, v68, v69
v_cvt_pk_bf16_f32 v77, v70, v71
v_cvt_pk_bf16_f32 v78, v72, v73
v_cvt_pk_bf16_f32 v79, v74, v75
buffer_store_dwordx4 v[76:79], v5, s[12:15], s58 offen offset:512 sc1
v_mfma_f32_16x16x32_bf16 a[108:111], v[216:219], a[240:243], a[108:111]
v_accvgpr_read_b32 v80, a11
v_accvgpr_read_b32 v81, a27
v_accvgpr_read_b32 v82, a43
v_accvgpr_read_b32 v83, a59
v_accvgpr_read_b32 v84, a75
v_accvgpr_read_b32 v85, a91
v_mfma_f32_16x16x32_bf16 a[108:111], v[232:235], a[244:247], a[108:111]
v_accvgpr_read_b32 v86, a107
v_accvgpr_read_b32 v87, a123
v_mul_f32 v80, v80, v151
v_mul_f32 v81, v81, v151
v_mul_f32 v82, v82, v151
v_mfma_f32_16x16x32_bf16 a[124:127], v[232:235], a[252:255], a[124:127]
v_mul_f32 v83, v83, v151
v_mul_f32 v84, v84, v151
v_mul_f32 v85, v85, v151
v_mul_f32 v86, v86, v151
v_mul_f32 v87, v87, v151
v_mfma_f32_16x16x32_bf16 a[124:127], v[216:219], a[248:251], a[124:127]
v_cvt_pk_bf16_f32 v88, v80, v81
v_cvt_pk_bf16_f32 v89, v82, v83
v_cvt_pk_bf16_f32 v90, v84, v85
v_cvt_pk_bf16_f32 v91, v86, v87
buffer_store_dwordx4 v[88:91], v5, s[12:15], s58 offen offset:768 sc1
s_nop 3
v_accvgpr_read_b32 v92, a12
v_accvgpr_read_b32 v93, a28
v_accvgpr_read_b32 v94, a44
v_accvgpr_read_b32 v95, a60
v_accvgpr_read_b32 v96, a76
v_accvgpr_read_b32 v97, a92
v_accvgpr_read_b32 v98, a108
v_accvgpr_read_b32 v99, a124
v_mul_f32 v92, v92, v152
v_mul_f32 v93, v93, v152
v_mul_f32 v94, v94, v152
v_mul_f32 v95, v95, v152
v_mul_f32 v96, v96, v152
v_mul_f32 v97, v97, v152
v_mul_f32 v98, v98, v152
v_mul_f32 v99, v99, v152
v_cvt_pk_bf16_f32 v100, v92, v93
v_cvt_pk_bf16_f32 v101, v94, v95
v_cvt_pk_bf16_f32 v102, v96, v97
v_cvt_pk_bf16_f32 v103, v98, v99
buffer_store_dwordx4 v[100:103], v5, s[12:15], s59 offen offset:0 sc1
v_accvgpr_read_b32 v104, a13
v_accvgpr_read_b32 v105, a29
v_accvgpr_read_b32 v106, a45
v_accvgpr_read_b32 v107, a61
v_accvgpr_read_b32 v108, a77
v_accvgpr_read_b32 v109, a93
v_accvgpr_read_b32 v110, a109
v_accvgpr_read_b32 v111, a125
v_mul_f32 v104, v104, v153
v_mul_f32 v105, v105, v153
v_mul_f32 v106, v106, v153
v_mul_f32 v107, v107, v153
v_mul_f32 v108, v108, v153
v_mul_f32 v109, v109, v153
v_mul_f32 v110, v110, v153
v_mul_f32 v111, v111, v153
v_cvt_pk_bf16_f32 v112, v104, v105
v_cvt_pk_bf16_f32 v113, v106, v107
v_cvt_pk_bf16_f32 v114, v108, v109
v_cvt_pk_bf16_f32 v115, v110, v111
buffer_store_dwordx4 v[112:115], v5, s[12:15], s59 offen offset:256 sc1
v_accvgpr_read_b32 v116, a14
v_accvgpr_read_b32 v117, a30
v_accvgpr_read_b32 v118, a46
v_accvgpr_read_b32 v119, a62
v_accvgpr_read_b32 v120, a78
v_accvgpr_read_b32 v121, a94
v_accvgpr_read_b32 v122, a110
v_accvgpr_read_b32 v123, a126
v_mul_f32 v116, v116, v154
v_mul_f32 v117, v117, v154
v_mul_f32 v118, v118, v154
v_mul_f32 v119, v119, v154
v_mul_f32 v120, v120, v154
v_mul_f32 v121, v121, v154
v_mul_f32 v122, v122, v154
v_mul_f32 v123, v123, v154
v_cvt_pk_bf16_f32 v124, v116, v117
v_cvt_pk_bf16_f32 v125, v118, v119
v_cvt_pk_bf16_f32 v126, v120, v121
v_cvt_pk_bf16_f32 v127, v122, v123
buffer_store_dwordx4 v[124:127], v5, s[12:15], s59 offen offset:512 sc1
v_accvgpr_read_b32 v128, a15
v_accvgpr_read_b32 v129, a31
v_accvgpr_read_b32 v130, a47
v_accvgpr_read_b32 v131, a63
v_accvgpr_read_b32 v132, a79
v_accvgpr_read_b32 v133, a95
v_accvgpr_read_b32 v134, a111
v_accvgpr_read_b32 v135, a127
v_mul_f32 v128, v128, v155
v_mul_f32 v129, v129, v155
v_mul_f32 v130, v130, v155
v_mul_f32 v131, v131, v155
v_mul_f32 v132, v132, v155
v_mul_f32 v133, v133, v155
v_mul_f32 v134, v134, v155
v_mul_f32 v135, v135, v155
v_cvt_pk_bf16_f32 v136, v128, v129
v_cvt_pk_bf16_f32 v137, v130, v131
v_cvt_pk_bf16_f32 v138, v132, v133
v_cvt_pk_bf16_f32 v139, v134, v135
buffer_store_dwordx4 v[136:139], v5, s[12:15], s59 offen offset:768 sc1
Lat_done:
s_endpgm
LB_slow:
s_cmp_lg_u32 s16, 1
s_cbranch_scc1 Lloop
s_mov_b32 s33, 131072
LpollB:
v_cmp_ne_u64 vcc, v[240:241], v[238:239]
s_cbranch_vccz Lloop
buffer_load_dwordx2 v[240:241], v236, s[68:71], 0 offen offset:512 sc1
s_sub_u32 s33, s33, 1
s_cmp_lg_u32 s33, 0
s_waitcnt vmcnt(0)
s_cbranch_scc1 LpollB
s_branch Lloop
Ltr_p0:
s_call_b64 s[22:23], Lrare_0
s_branch Lbk_p0
Ltr_l1:
s_call_b64 s[22:23], Lrare_1
s_branch Lbk_l1
Ltr_l2:
s_call_b64 s[22:23], Lrare_0
s_branch Lbk_l2
Ltr_t31:
s_call_b64 s[22:23], Lrare_1
s_branch Lbk_t31
Lrare_0:
s_nop 7
s_nop 7
v_max3_f32 v20, v44, v45, v46
v_max3_f32 v20, v20, v47, v60
v_max3_f32 v20, v20, v61, v62
v_max3_f32 v20, v20, v63, v76
v_max3_f32 v20, v20, v77, v78
v_max3_f32 v20, v20, v79, v92
v_max3_f32 v20, v20, v93, v94
v_max3_f32 v20, v20, v95, 0
v_max3_f32 v21, v48, v49, v50
v_max3_f32 v21, v21, v51, v64
v_max3_f32 v21, v21, v65, v66
v_max3_f32 v21, v21, v67, v80
v_max3_f32 v21, v21, v81, v82
v_max3_f32 v21, v21, v83, v96
v_max3_f32 v21, v21, v97, v98
v_max3_f32 v21, v21, v99, 0
v_max3_f32 v22, v52, v53, v54
v_max3_f32 v22, v22, v55, v68
v_max3_f32 v22, v22, v69, v70
v_max3_f32 v22, v22, v71, v84
v_max3_f32 v22, v22, v85, v86
v_max3_f32 v22, v22, v87, v100
v_max3_f32 v22, v22, v101, v102
v_max3_f32 v22, v22, v103, 0
v_max3_f32 v23, v56, v57, v58
v_max3_f32 v23, v23, v59, v72
v_max3_f32 v23, v23, v73, v74
v_max3_f32 v23, v23, v75, v88
v_max3_f32 v23, v23, v89, v90
v_max3_f32 v23, v23, v91, v104
v_max3_f32 v23, v23, v105, v106
v_max3_f32 v23, v23, v107, 0
v_mov_b32 v24, v20
v_mov_b32 v25, v21
v_mov_b32 v26, v22
v_mov_b32 v27, v23
v_permlane32_swap_b32 v20, v24
v_permlane32_swap_b32 v21, v25
v_permlane32_swap_b32 v22, v26
v_permlane32_swap_b32 v23, v27
v_max_f32 v20, v20, v24
v_max_f32 v21, v21, v25
v_max_f32 v22, v22, v26
v_max_f32 v23, v23, v27
v_mov_b32 v24, v20
v_mov_b32 v25, v21
v_mov_b32 v26, v22
v_mov_b32 v27, v23
v_permlane16_swap_b32 v20, v24
v_permlane16_swap_b32 v21, v25
v_permlane16_swap_b32 v22, v26
v_permlane16_swap_b32 v23, v27
v_max_f32 v20, v20, v24
v_max_f32 v21, v21, v25
v_max_f32 v22, v22, v26
v_max_f32 v23, v23, v27
v_exp_f32 v24, -v20
v_exp_f32 v25, -v21
v_exp_f32 v26, -v22
v_exp_f32 v27, -v23
v_sub_f32 v44, v44, v20
v_sub_f32 v45, v45, v20
v_sub_f32 v46, v46, v20
v_sub_f32 v47, v47, v20
v_sub_f32 v60, v60, v20
v_sub_f32 v61, v61, v20
v_sub_f32 v62, v62, v20
v_sub_f32 v63, v63, v20
v_sub_f32 v76, v76, v20
v_sub_f32 v77, v77, v20
v_sub_f32 v78, v78, v20
v_sub_f32 v79, v79, v20
v_sub_f32 v92, v92, v20
v_sub_f32 v93, v93, v20
v_sub_f32 v94, v94, v20
v_sub_f32 v95, v95, v20
v_sub_f32 v108, v108, v20
v_sub_f32 v109, v109, v20
v_sub_f32 v110, v110, v20
v_sub_f32 v111, v111, v20
v_sub_f32 v124, v124, v20
v_sub_f32 v125, v125, v20
v_sub_f32 v126, v126, v20
v_sub_f32 v127, v127, v20
v_sub_f32 v140, v140, v20
v_sub_f32 v141, v141, v20
v_sub_f32 v142, v142, v20
v_sub_f32 v143, v143, v20
v_sub_f32 v156, v156, v20
v_sub_f32 v157, v157, v20
v_sub_f32 v158, v158, v20
v_sub_f32 v159, v159, v20
v_sub_f32 v28, v28, v20
v_sub_f32 v29, v29, v20
v_sub_f32 v30, v30, v20
v_sub_f32 v31, v31, v20
v_mul_f32 v16, v16, v24
v_sub_f32 v48, v48, v21
v_sub_f32 v49, v49, v21
v_sub_f32 v50, v50, v21
v_sub_f32 v51, v51, v21
v_sub_f32 v64, v64, v21
v_sub_f32 v65, v65, v21
v_sub_f32 v66, v66, v21
v_sub_f32 v67, v67, v21
v_sub_f32 v80, v80, v21
v_sub_f32 v81, v81, v21
v_sub_f32 v82, v82, v21
v_sub_f32 v83, v83, v21
v_sub_f32 v96, v96, v21
v_sub_f32 v97, v97, v21
v_sub_f32 v98, v98, v21
v_sub_f32 v99, v99, v21
v_sub_f32 v112, v112, v21
v_sub_f32 v113, v113, v21
v_sub_f32 v114, v114, v21
v_sub_f32 v115, v115, v21
v_sub_f32 v128, v128, v21
v_sub_f32 v129, v129, v21
v_sub_f32 v130, v130, v21
v_sub_f32 v131, v131, v21
v_sub_f32 v144, v144, v21
v_sub_f32 v145, v145, v21
v_sub_f32 v146, v146, v21
v_sub_f32 v147, v147, v21
v_sub_f32 v160, v160, v21
v_sub_f32 v161, v161, v21
v_sub_f32 v162, v162, v21
v_sub_f32 v163, v163, v21
v_sub_f32 v32, v32, v21
v_sub_f32 v33, v33, v21
v_sub_f32 v34, v34, v21
v_sub_f32 v35, v35, v21
v_mul_f32 v17, v17, v25
v_sub_f32 v52, v52, v22
v_sub_f32 v53, v53, v22
v_sub_f32 v54, v54, v22
v_sub_f32 v55, v55, v22
v_sub_f32 v68, v68, v22
v_sub_f32 v69, v69, v22
v_sub_f32 v70, v70, v22
v_sub_f32 v71, v71, v22
v_sub_f32 v84, v84, v22
v_sub_f32 v85, v85, v22
v_sub_f32 v86, v86, v22
v_sub_f32 v87, v87, v22
v_sub_f32 v100, v100, v22
v_sub_f32 v101, v101, v22
v_sub_f32 v102, v102, v22
v_sub_f32 v103, v103, v22
v_sub_f32 v116, v116, v22
v_sub_f32 v117, v117, v22
v_sub_f32 v118, v118, v22
v_sub_f32 v119, v119, v22
v_sub_f32 v132, v132, v22
v_sub_f32 v133, v133, v22
v_sub_f32 v134, v134, v22
v_sub_f32 v135, v135, v22
v_sub_f32 v148, v148, v22
v_sub_f32 v149, v149, v22
v_sub_f32 v150, v150, v22
v_sub_f32 v151, v151, v22
v_sub_f32 v164, v164, v22
v_sub_f32 v165, v165, v22
v_sub_f32 v166, v166, v22
v_sub_f32 v167, v167, v22
v_sub_f32 v36, v36, v22
v_sub_f32 v37, v37, v22
v_sub_f32 v38, v38, v22
v_sub_f32 v39, v39, v22
v_mul_f32 v18, v18, v26
v_sub_f32 v56, v56, v23
v_sub_f32 v57, v57, v23
v_sub_f32 v58, v58, v23
v_sub_f32 v59, v59, v23
v_sub_f32 v72, v72, v23
v_sub_f32 v73, v73, v23
v_sub_f32 v74, v74, v23
v_sub_f32 v75, v75, v23
v_sub_f32 v88, v88, v23
v_sub_f32 v89, v89, v23
v_sub_f32 v90, v90, v23
v_sub_f32 v91, v91, v23
v_sub_f32 v104, v104, v23
v_sub_f32 v105, v105, v23
v_sub_f32 v106, v106, v23
v_sub_f32 v107, v107, v23
v_sub_f32 v120, v120, v23
v_sub_f32 v121, v121, v23
v_sub_f32 v122, v122, v23
v_sub_f32 v123, v123, v23
v_sub_f32 v136, v136, v23
v_sub_f32 v137, v137, v23
v_sub_f32 v138, v138, v23
v_sub_f32 v139, v139, v23
v_sub_f32 v152, v152, v23
v_sub_f32 v153, v153, v23
v_sub_f32 v154, v154, v23
v_sub_f32 v155, v155, v23
v_sub_f32 v168, v168, v23
v_sub_f32 v169, v169, v23
v_sub_f32 v170, v170, v23
v_sub_f32 v171, v171, v23
v_sub_f32 v40, v40, v23
v_sub_f32 v41, v41, v23
v_sub_f32 v42, v42, v23
v_sub_f32 v43, v43, v23
v_mul_f32 v19, v19, v27
ds_bpermute_b32 v242, v4, v24 offset:0
ds_bpermute_b32 v243, v4, v24 offset:4
ds_bpermute_b32 v244, v4, v24 offset:8
ds_bpermute_b32 v245, v4, v24 offset:12
s_waitcnt lgkmcnt(0)
v_accvgpr_read_b32 v20, a0
v_accvgpr_read_b32 v21, a1
v_accvgpr_read_b32 v22, a2
v_accvgpr_read_b32 v23, a3
v_mul_f32 v20, v20, v242
v_mul_f32 v21, v21, v243
v_mul_f32 v22, v22, v244
v_mul_f32 v23, v23, v245
v_accvgpr_write_b32 a0, v20
v_accvgpr_write_b32 a1, v21
v_accvgpr_write_b32 a2, v22
v_accvgpr_write_b32 a3, v23
v_accvgpr_read_b32 v20, a16
v_accvgpr_read_b32 v21, a17
v_accvgpr_read_b32 v22, a18
v_accvgpr_read_b32 v23, a19
v_mul_f32 v20, v20, v242
v_mul_f32 v21, v21, v243
v_mul_f32 v22, v22, v244
v_mul_f32 v23, v23, v245
v_accvgpr_write_b32 a16, v20
v_accvgpr_write_b32 a17, v21
v_accvgpr_write_b32 a18, v22
v_accvgpr_write_b32 a19, v23
v_accvgpr_read_b32 v20, a32
v_accvgpr_read_b32 v21, a33
v_accvgpr_read_b32 v22, a34
v_accvgpr_read_b32 v23, a35
v_mul_f32 v20, v20, v242
v_mul_f32 v21, v21, v243
v_mul_f32 v22, v22, v244
v_mul_f32 v23, v23, v245
v_accvgpr_write_b32 a32, v20
v_accvgpr_write_b32 a33, v21
v_accvgpr_write_b32 a34, v22
v_accvgpr_write_b32 a35, v23
v_accvgpr_read_b32 v20, a48
v_accvgpr_read_b32 v21, a49
v_accvgpr_read_b32 v22, a50
v_accvgpr_read_b32 v23, a51
v_mul_f32 v20, v20, v242
v_mul_f32 v21, v21, v243
v_mul_f32 v22, v22, v244
v_mul_f32 v23, v23, v245
v_accvgpr_write_b32 a48, v20
v_accvgpr_write_b32 a49, v21
v_accvgpr_write_b32 a50, v22
v_accvgpr_write_b32 a51, v23
v_accvgpr_read_b32 v20, a64
v_accvgpr_read_b32 v21, a65
v_accvgpr_read_b32 v22, a66
v_accvgpr_read_b32 v23, a67
v_mul_f32 v20, v20, v242
v_mul_f32 v21, v21, v243
v_mul_f32 v22, v22, v244
v_mul_f32 v23, v23, v245
v_accvgpr_write_b32 a64, v20
v_accvgpr_write_b32 a65, v21
v_accvgpr_write_b32 a66, v22
v_accvgpr_write_b32 a67, v23
v_accvgpr_read_b32 v20, a80
v_accvgpr_read_b32 v21, a81
v_accvgpr_read_b32 v22, a82
v_accvgpr_read_b32 v23, a83
v_mul_f32 v20, v20, v242
v_mul_f32 v21, v21, v243
v_mul_f32 v22, v22, v244
v_mul_f32 v23, v23, v245
v_accvgpr_write_b32 a80, v20
v_accvgpr_write_b32 a81, v21
v_accvgpr_write_b32 a82, v22
v_accvgpr_write_b32 a83, v23
v_accvgpr_read_b32 v20, a96
v_accvgpr_read_b32 v21, a97
v_accvgpr_read_b32 v22, a98
v_accvgpr_read_b32 v23, a99
v_mul_f32 v20, v20, v242
v_mul_f32 v21, v21, v243
v_mul_f32 v22, v22, v244
v_mul_f32 v23, v23, v245
v_accvgpr_write_b32 a96, v20
v_accvgpr_write_b32 a97, v21
v_accvgpr_write_b32 a98, v22
v_accvgpr_write_b32 a99, v23
v_accvgpr_read_b32 v20, a112
v_accvgpr_read_b32 v21, a113
v_accvgpr_read_b32 v22, a114
v_accvgpr_read_b32 v23, a115
v_mul_f32 v20, v20, v242
v_mul_f32 v21, v21, v243
v_mul_f32 v22, v22, v244
v_mul_f32 v23, v23, v245
v_accvgpr_write_b32 a112, v20
v_accvgpr_write_b32 a113, v21
v_accvgpr_write_b32 a114, v22
v_accvgpr_write_b32 a115, v23
ds_bpermute_b32 v242, v4, v25 offset:0
ds_bpermute_b32 v243, v4, v25 offset:4
ds_bpermute_b32 v244, v4, v25 offset:8
ds_bpermute_b32 v245, v4, v25 offset:12
s_waitcnt lgkmcnt(0)
v_accvgpr_read_b32 v20, a4
v_accvgpr_read_b32 v21, a5
v_accvgpr_read_b32 v22, a6
v_accvgpr_read_b32 v23, a7
v_mul_f32 v20, v20, v242
v_mul_f32 v21, v21, v243
v_mul_f32 v22, v22, v244
v_mul_f32 v23, v23, v245
v_accvgpr_write_b32 a4, v20
v_accvgpr_write_b32 a5, v21
v_accvgpr_write_b32 a6, v22
v_accvgpr_write_b32 a7, v23
v_accvgpr_read_b32 v20, a20
v_accvgpr_read_b32 v21, a21
v_accvgpr_read_b32 v22, a22
v_accvgpr_read_b32 v23, a23
v_mul_f32 v20, v20, v242
v_mul_f32 v21, v21, v243
v_mul_f32 v22, v22, v244
v_mul_f32 v23, v23, v245
v_accvgpr_write_b32 a20, v20
v_accvgpr_write_b32 a21, v21
v_accvgpr_write_b32 a22, v22
v_accvgpr_write_b32 a23, v23
v_accvgpr_read_b32 v20, a36
v_accvgpr_read_b32 v21, a37
v_accvgpr_read_b32 v22, a38
v_accvgpr_read_b32 v23, a39
v_mul_f32 v20, v20, v242
v_mul_f32 v21, v21, v243
v_mul_f32 v22, v22, v244
v_mul_f32 v23, v23, v245
v_accvgpr_write_b32 a36, v20
v_accvgpr_write_b32 a37, v21
v_accvgpr_write_b32 a38, v22
v_accvgpr_write_b32 a39, v23
v_accvgpr_read_b32 v20, a52
v_accvgpr_read_b32 v21, a53
v_accvgpr_read_b32 v22, a54
v_accvgpr_read_b32 v23, a55
v_mul_f32 v20, v20, v242
v_mul_f32 v21, v21, v243
v_mul_f32 v22, v22, v244
v_mul_f32 v23, v23, v245
v_accvgpr_write_b32 a52, v20
v_accvgpr_write_b32 a53, v21
v_accvgpr_write_b32 a54, v22
v_accvgpr_write_b32 a55, v23
v_accvgpr_read_b32 v20, a68
v_accvgpr_read_b32 v21, a69
v_accvgpr_read_b32 v22, a70
v_accvgpr_read_b32 v23, a71
v_mul_f32 v20, v20, v242
v_mul_f32 v21, v21, v243
v_mul_f32 v22, v22, v244
v_mul_f32 v23, v23, v245
v_accvgpr_write_b32 a68, v20
v_accvgpr_write_b32 a69, v21
v_accvgpr_write_b32 a70, v22
v_accvgpr_write_b32 a71, v23
v_accvgpr_read_b32 v20, a84
v_accvgpr_read_b32 v21, a85
v_accvgpr_read_b32 v22, a86
v_accvgpr_read_b32 v23, a87
v_mul_f32 v20, v20, v242
v_mul_f32 v21, v21, v243
v_mul_f32 v22, v22, v244
v_mul_f32 v23, v23, v245
v_accvgpr_write_b32 a84, v20
v_accvgpr_write_b32 a85, v21
v_accvgpr_write_b32 a86, v22
v_accvgpr_write_b32 a87, v23
v_accvgpr_read_b32 v20, a100
v_accvgpr_read_b32 v21, a101
v_accvgpr_read_b32 v22, a102
v_accvgpr_read_b32 v23, a103
v_mul_f32 v20, v20, v242
v_mul_f32 v21, v21, v243
v_mul_f32 v22, v22, v244
v_mul_f32 v23, v23, v245
v_accvgpr_write_b32 a100, v20
v_accvgpr_write_b32 a101, v21
v_accvgpr_write_b32 a102, v22
v_accvgpr_write_b32 a103, v23
v_accvgpr_read_b32 v20, a116
v_accvgpr_read_b32 v21, a117
v_accvgpr_read_b32 v22, a118
v_accvgpr_read_b32 v23, a119
v_mul_f32 v20, v20, v242
v_mul_f32 v21, v21, v243
v_mul_f32 v22, v22, v244
v_mul_f32 v23, v23, v245
v_accvgpr_write_b32 a116, v20
v_accvgpr_write_b32 a117, v21
v_accvgpr_write_b32 a118, v22
v_accvgpr_write_b32 a119, v23
ds_bpermute_b32 v242, v4, v26 offset:0
ds_bpermute_b32 v243, v4, v26 offset:4
ds_bpermute_b32 v244, v4, v26 offset:8
ds_bpermute_b32 v245, v4, v26 offset:12
s_waitcnt lgkmcnt(0)
v_accvgpr_read_b32 v20, a8
v_accvgpr_read_b32 v21, a9
v_accvgpr_read_b32 v22, a10
v_accvgpr_read_b32 v23, a11
v_mul_f32 v20, v20, v242
v_mul_f32 v21, v21, v243
v_mul_f32 v22, v22, v244
v_mul_f32 v23, v23, v245
v_accvgpr_write_b32 a8, v20
v_accvgpr_write_b32 a9, v21
v_accvgpr_write_b32 a10, v22
v_accvgpr_write_b32 a11, v23
v_accvgpr_read_b32 v20, a24
v_accvgpr_read_b32 v21, a25
v_accvgpr_read_b32 v22, a26
v_accvgpr_read_b32 v23, a27
v_mul_f32 v20, v20, v242
v_mul_f32 v21, v21, v243
v_mul_f32 v22, v22, v244
v_mul_f32 v23, v23, v245
v_accvgpr_write_b32 a24, v20
v_accvgpr_write_b32 a25, v21
v_accvgpr_write_b32 a26, v22
v_accvgpr_write_b32 a27, v23
v_accvgpr_read_b32 v20, a40
v_accvgpr_read_b32 v21, a41
v_accvgpr_read_b32 v22, a42
v_accvgpr_read_b32 v23, a43
v_mul_f32 v20, v20, v242
v_mul_f32 v21, v21, v243
v_mul_f32 v22, v22, v244
v_mul_f32 v23, v23, v245
v_accvgpr_write_b32 a40, v20
v_accvgpr_write_b32 a41, v21
v_accvgpr_write_b32 a42, v22
v_accvgpr_write_b32 a43, v23
v_accvgpr_read_b32 v20, a56
v_accvgpr_read_b32 v21, a57
v_accvgpr_read_b32 v22, a58
v_accvgpr_read_b32 v23, a59
v_mul_f32 v20, v20, v242
v_mul_f32 v21, v21, v243
v_mul_f32 v22, v22, v244
v_mul_f32 v23, v23, v245
v_accvgpr_write_b32 a56, v20
v_accvgpr_write_b32 a57, v21
v_accvgpr_write_b32 a58, v22
v_accvgpr_write_b32 a59, v23
v_accvgpr_read_b32 v20, a72
v_accvgpr_read_b32 v21, a73
v_accvgpr_read_b32 v22, a74
v_accvgpr_read_b32 v23, a75
v_mul_f32 v20, v20, v242
v_mul_f32 v21, v21, v243
v_mul_f32 v22, v22, v244
v_mul_f32 v23, v23, v245
v_accvgpr_write_b32 a72, v20
v_accvgpr_write_b32 a73, v21
v_accvgpr_write_b32 a74, v22
v_accvgpr_write_b32 a75, v23
v_accvgpr_read_b32 v20, a88
v_accvgpr_read_b32 v21, a89
v_accvgpr_read_b32 v22, a90
v_accvgpr_read_b32 v23, a91
v_mul_f32 v20, v20, v242
v_mul_f32 v21, v21, v243
v_mul_f32 v22, v22, v244
v_mul_f32 v23, v23, v245
v_accvgpr_write_b32 a88, v20
v_accvgpr_write_b32 a89, v21
v_accvgpr_write_b32 a90, v22
v_accvgpr_write_b32 a91, v23
v_accvgpr_read_b32 v20, a104
v_accvgpr_read_b32 v21, a105
v_accvgpr_read_b32 v22, a106
v_accvgpr_read_b32 v23, a107
v_mul_f32 v20, v20, v242
v_mul_f32 v21, v21, v243
v_mul_f32 v22, v22, v244
v_mul_f32 v23, v23, v245
v_accvgpr_write_b32 a104, v20
v_accvgpr_write_b32 a105, v21
v_accvgpr_write_b32 a106, v22
v_accvgpr_write_b32 a107, v23
v_accvgpr_read_b32 v20, a120
v_accvgpr_read_b32 v21, a121
v_accvgpr_read_b32 v22, a122
v_accvgpr_read_b32 v23, a123
v_mul_f32 v20, v20, v242
v_mul_f32 v21, v21, v243
v_mul_f32 v22, v22, v244
v_mul_f32 v23, v23, v245
v_accvgpr_write_b32 a120, v20
v_accvgpr_write_b32 a121, v21
v_accvgpr_write_b32 a122, v22
v_accvgpr_write_b32 a123, v23
ds_bpermute_b32 v242, v4, v27 offset:0
ds_bpermute_b32 v243, v4, v27 offset:4
ds_bpermute_b32 v244, v4, v27 offset:8
ds_bpermute_b32 v245, v4, v27 offset:12
s_waitcnt lgkmcnt(0)
v_accvgpr_read_b32 v20, a12
v_accvgpr_read_b32 v21, a13
v_accvgpr_read_b32 v22, a14
v_accvgpr_read_b32 v23, a15
v_mul_f32 v20, v20, v242
v_mul_f32 v21, v21, v243
v_mul_f32 v22, v22, v244
v_mul_f32 v23, v23, v245
v_accvgpr_write_b32 a12, v20
v_accvgpr_write_b32 a13, v21
v_accvgpr_write_b32 a14, v22
v_accvgpr_write_b32 a15, v23
v_accvgpr_read_b32 v20, a28
v_accvgpr_read_b32 v21, a29
v_accvgpr_read_b32 v22, a30
v_accvgpr_read_b32 v23, a31
v_mul_f32 v20, v20, v242
v_mul_f32 v21, v21, v243
v_mul_f32 v22, v22, v244
v_mul_f32 v23, v23, v245
v_accvgpr_write_b32 a28, v20
v_accvgpr_write_b32 a29, v21
v_accvgpr_write_b32 a30, v22
v_accvgpr_write_b32 a31, v23
v_accvgpr_read_b32 v20, a44
v_accvgpr_read_b32 v21, a45
v_accvgpr_read_b32 v22, a46
v_accvgpr_read_b32 v23, a47
v_mul_f32 v20, v20, v242
v_mul_f32 v21, v21, v243
v_mul_f32 v22, v22, v244
v_mul_f32 v23, v23, v245
v_accvgpr_write_b32 a44, v20
v_accvgpr_write_b32 a45, v21
v_accvgpr_write_b32 a46, v22
v_accvgpr_write_b32 a47, v23
v_accvgpr_read_b32 v20, a60
v_accvgpr_read_b32 v21, a61
v_accvgpr_read_b32 v22, a62
v_accvgpr_read_b32 v23, a63
v_mul_f32 v20, v20, v242
v_mul_f32 v21, v21, v243
v_mul_f32 v22, v22, v244
v_mul_f32 v23, v23, v245
v_accvgpr_write_b32 a60, v20
v_accvgpr_write_b32 a61, v21
v_accvgpr_write_b32 a62, v22
v_accvgpr_write_b32 a63, v23
v_accvgpr_read_b32 v20, a76
v_accvgpr_read_b32 v21, a77
v_accvgpr_read_b32 v22, a78
v_accvgpr_read_b32 v23, a79
v_mul_f32 v20, v20, v242
v_mul_f32 v21, v21, v243
v_mul_f32 v22, v22, v244
v_mul_f32 v23, v23, v245
v_accvgpr_write_b32 a76, v20
v_accvgpr_write_b32 a77, v21
v_accvgpr_write_b32 a78, v22
v_accvgpr_write_b32 a79, v23
v_accvgpr_read_b32 v20, a92
v_accvgpr_read_b32 v21, a93
v_accvgpr_read_b32 v22, a94
v_accvgpr_read_b32 v23, a95
v_mul_f32 v20, v20, v242
v_mul_f32 v21, v21, v243
v_mul_f32 v22, v22, v244
v_mul_f32 v23, v23, v245
v_accvgpr_write_b32 a92, v20
v_accvgpr_write_b32 a93, v21
v_accvgpr_write_b32 a94, v22
v_accvgpr_write_b32 a95, v23
v_accvgpr_read_b32 v20, a108
v_accvgpr_read_b32 v21, a109
v_accvgpr_read_b32 v22, a110
v_accvgpr_read_b32 v23, a111
v_mul_f32 v20, v20, v242
v_mul_f32 v21, v21, v243
v_mul_f32 v22, v22, v244
v_mul_f32 v23, v23, v245
v_accvgpr_write_b32 a108, v20
v_accvgpr_write_b32 a109, v21
v_accvgpr_write_b32 a110, v22
v_accvgpr_write_b32 a111, v23
v_accvgpr_read_b32 v20, a124
v_accvgpr_read_b32 v21, a125
v_accvgpr_read_b32 v22, a126
v_accvgpr_read_b32 v23, a127
v_mul_f32 v20, v20, v242
v_mul_f32 v21, v21, v243
v_mul_f32 v22, v22, v244
v_mul_f32 v23, v23, v245
v_accvgpr_write_b32 a124, v20
v_accvgpr_write_b32 a125, v21
v_accvgpr_write_b32 a126, v22
v_accvgpr_write_b32 a127, v23
v_exp_f32 v20, v44
v_exp_f32 v21, v45
v_exp_f32 v22, v46
v_exp_f32 v23, v47
v_add_f32 v8, v20, v21
v_cvt_pk_bf16_f32 v172, v20, v21
v_exp_f32 v24, v48
v_exp_f32 v25, v49
v_add_f32 v8, v8, v22
v_add_f32 v8, v8, v23
v_cvt_pk_bf16_f32 v173, v22, v23
v_exp_f32 v26, v50
v_exp_f32 v27, v51
v_add_f32 v9, v24, v25
v_cvt_pk_bf16_f32 v176, v24, v25
v_exp_f32 v20, v52
v_exp_f32 v21, v53
v_add_f32 v9, v9, v26
v_add_f32 v9, v9, v27
v_cvt_pk_bf16_f32 v177, v26, v27
v_exp_f32 v22, v54
v_exp_f32 v23, v55
v_add_f32 v10, v20, v21
v_cvt_pk_bf16_f32 v180, v20, v21
v_exp_f32 v24, v56
v_exp_f32 v25, v57
v_add_f32 v10, v10, v22
v_add_f32 v10, v10, v23
v_cvt_pk_bf16_f32 v181, v22, v23
v_exp_f32 v26, v58
v_exp_f32 v27, v59
v_add_f32 v11, v24, v25
v_cvt_pk_bf16_f32 v184, v24, v25
v_exp_f32 v20, v60
v_exp_f32 v21, v61
v_add_f32 v11, v11, v26
v_add_f32 v11, v11, v27
v_cvt_pk_bf16_f32 v185, v26, v27
v_exp_f32 v22, v62
v_exp_f32 v23, v63
v_add_f32 v8, v8, v20
v_add_f32 v8, v8, v21
v_cvt_pk_bf16_f32 v174, v20, v21
v_exp_f32 v24, v64
v_exp_f32 v25, v65
v_add_f32 v8, v8, v22
v_add_f32 v8, v8, v23
v_cvt_pk_bf16_f32 v175, v22, v23
v_exp_f32 v26, v66
v_exp_f32 v27, v67
v_add_f32 v9, v9, v24
v_add_f32 v9, v9, v25
v_cvt_pk_bf16_f32 v178, v24, v25
v_exp_f32 v20, v68
v_exp_f32 v21, v69
v_add_f32 v9, v9, v26
v_add_f32 v9, v9, v27
v_cvt_pk_bf16_f32 v179, v26, v27
v_exp_f32 v22, v70
v_exp_f32 v23, v71
v_add_f32 v10, v10, v20
v_add_f32 v10, v10, v21
v_cvt_pk_bf16_f32 v182, v20, v21
v_exp_f32 v24, v72
v_exp_f32 v25, v73
v_add_f32 v10, v10, v22
v_add_f32 v10, v10, v23
v_cvt_pk_bf16_f32 v183, v22, v23
v_exp_f32 v26, v74
v_exp_f32 v27, v75
v_add_f32 v11, v11, v24
v_add_f32 v11, v11, v25
v_cvt_pk_bf16_f32 v186, v24, v25
v_exp_f32 v20, v76
v_exp_f32 v21, v77
v_add_f32 v11, v11, v26
v_add_f32 v11, v11, v27
v_cvt_pk_bf16_f32 v187, v26, v27
v_exp_f32 v22, v78
v_exp_f32 v23, v79
v_add_f32 v8, v8, v20
v_add_f32 v8, v8, v21
v_cvt_pk_bf16_f32 v188, v20, v21
v_exp_f32 v24, v80
v_exp_f32 v25, v81
v_add_f32 v8, v8, v22
v_add_f32 v8, v8, v23
v_cvt_pk_bf16_f32 v189, v22, v23
v_exp_f32 v26, v82
v_exp_f32 v27, v83
v_add_f32 v9, v9, v24
v_add_f32 v9, v9, v25
v_cvt_pk_bf16_f32 v192, v24, v25
v_exp_f32 v20, v84
v_exp_f32 v21, v85
v_add_f32 v9, v9, v26
v_add_f32 v9, v9, v27
v_cvt_pk_bf16_f32 v193, v26, v27
v_exp_f32 v22, v86
v_exp_f32 v23, v87
v_add_f32 v10, v10, v20
v_add_f32 v10, v10, v21
v_cvt_pk_bf16_f32 v196, v20, v21
v_exp_f32 v24, v88
v_exp_f32 v25, v89
v_add_f32 v10, v10, v22
v_add_f32 v10, v10, v23
v_cvt_pk_bf16_f32 v197, v22, v23
v_exp_f32 v26, v90
v_exp_f32 v27, v91
v_add_f32 v11, v11, v24
v_add_f32 v11, v11, v25
v_cvt_pk_bf16_f32 v200, v24, v25
v_exp_f32 v20, v92
v_exp_f32 v21, v93
v_add_f32 v11, v11, v26
v_add_f32 v11, v11, v27
v_cvt_pk_bf16_f32 v201, v26, v27
v_exp_f32 v22, v94
v_exp_f32 v23, v95
v_add_f32 v8, v8, v20
v_add_f32 v8, v8, v21
v_cvt_pk_bf16_f32 v190, v20, v21
v_exp_f32 v24, v96
v_exp_f32 v25, v97
v_add_f32 v8, v8, v22
v_add_f32 v8, v8, v23
v_cvt_pk_bf16_f32 v191, v22, v23
v_exp_f32 v26, v98
v_exp_f32 v27, v99
v_add_f32 v9, v9, v24
v_add_f32 v9, v9, v25
v_cvt_pk_bf16_f32 v194, v24, v25
v_exp_f32 v20, v100
v_exp_f32 v21, v101
v_add_f32 v9, v9, v26
v_add_f32 v9, v9, v27
v_cvt_pk_bf16_f32 v195, v26, v27
v_exp_f32 v22, v102
v_exp_f32 v23, v103
v_add_f32 v10, v10, v20
v_add_f32 v10, v10, v21
v_cvt_pk_bf16_f32 v198, v20, v21
v_exp_f32 v24, v104
v_exp_f32 v25, v105
v_add_f32 v10, v10, v22
v_add_f32 v10, v10, v23
v_cvt_pk_bf16_f32 v199, v22, v23
v_exp_f32 v26, v106
v_exp_f32 v27, v107
v_add_f32 v11, v11, v24
v_add_f32 v11, v11, v25
v_cvt_pk_bf16_f32 v202, v24, v25
s_nop 0
v_add_f32 v11, v11, v26
v_add_f32 v11, v11, v27
v_cvt_pk_bf16_f32 v203, v26, v27
s_nop 0
v_exp_f32 v20, v108
s_nop 0
v_exp_f32 v21, v109
s_nop 0
v_exp_f32 v22, v110
s_nop 0
v_add_f32 v12, v20, v21
s_nop 0
v_exp_f32 v23, v111
s_nop 0
v_cvt_pk_bf16_f32 v204, v20, v21
s_nop 0
v_exp_f32 v24, v112
s_nop 0
v_add_f32 v12, v12, v22
s_nop 0
v_add_f32 v12, v12, v23
s_nop 0
v_exp_f32 v25, v113
s_nop 0
v_cvt_pk_bf16_f32 v205, v22, v23
s_nop 3
s_setpc_b64 s[22:23]
Lrare_1:
s_nop 7
s_nop 7
v_max3_f32 v20, v108, v109, v110
v_max3_f32 v20, v20, v111, v124
v_max3_f32 v20, v20, v125, v126
v_max3_f32 v20, v20, v127, v140
v_max3_f32 v20, v20, v141, v142
v_max3_f32 v20, v20, v143, v156
v_max3_f32 v20, v20, v157, v158
v_max3_f32 v20, v20, v159, 0
v_max3_f32 v21, v112, v113, v114
v_max3_f32 v21, v21, v115, v128
v_max3_f32 v21, v21, v129, v130
v_max3_f32 v21, v21, v131, v144
v_max3_f32 v21, v21, v145, v146
v_max3_f32 v21, v21, v147, v160
v_max3_f32 v21, v21, v161, v162
v_max3_f32 v21, v21, v163, 0
v_max3_f32 v22, v116, v117, v118
v_max3_f32 v22, v22, v119, v132
v_max3_f32 v22, v22, v133, v134
v_max3_f32 v22, v22, v135, v148
v_max3_f32 v22, v22, v149, v150
v_max3_f32 v22, v22, v151, v164
v_max3_f32 v22, v22, v165, v166
v_max3_f32 v22, v22, v167, 0
v_max3_f32 v23, v120, v121, v122
v_max3_f32 v23, v23, v123, v136
v_max3_f32 v23, v23, v137, v138
v_max3_f32 v23, v23, v139, v152
v_max3_f32 v23, v23, v153, v154
v_max3_f32 v23, v23, v155, v168
v_max3_f32 v23, v23, v169, v170
v_max3_f32 v23, v23, v171, 0
v_mov_b32 v24, v20
v_mov_b32 v25, v21
v_mov_b32 v26, v22
v_mov_b32 v27, v23
v_permlane32_swap_b32 v20, v24
v_permlane32_swap_b32 v21, v25
v_permlane32_swap_b32 v22, v26
v_permlane32_swap_b32 v23, v27
v_max_f32 v20, v20, v24
v_max_f32 v21, v21, v25
v_max_f32 v22, v22, v26
v_max_f32 v23, v23, v27
v_mov_b32 v24, v20
v_mov_b32 v25, v21
v_mov_b32 v26, v22
v_mov_b32 v27, v23
v_permlane16_swap_b32 v20, v24
v_permlane16_swap_b32 v21, v25
v_permlane16_swap_b32 v22, v26
v_permlane16_swap_b32 v23, v27
v_max_f32 v20, v20, v24
v_max_f32 v21, v21, v25
v_max_f32 v22, v22, v26
v_max_f32 v23, v23, v27
v_exp_f32 v24, -v20
v_exp_f32 v25, -v21
v_exp_f32 v26, -v22
v_exp_f32 v27, -v23
v_sub_f32 v44, v44, v20
v_sub_f32 v45, v45, v20
v_sub_f32 v46, v46, v20
v_sub_f32 v47, v47, v20
v_sub_f32 v60, v60, v20
v_sub_f32 v61, v61, v20
v_sub_f32 v62, v62, v20
v_sub_f32 v63, v63, v20
v_sub_f32 v76, v76, v20
v_sub_f32 v77, v77, v20
v_sub_f32 v78, v78, v20
v_sub_f32 v79, v79, v20
v_sub_f32 v92, v92, v20
v_sub_f32 v93, v93, v20
v_sub_f32 v94, v94, v20
v_sub_f32 v95, v95, v20
v_sub_f32 v108, v108, v20
v_sub_f32 v109, v109, v20
v_sub_f32 v110, v110, v20
v_sub_f32 v111, v111, v20
v_sub_f32 v124, v124, v20
v_sub_f32 v125, v125, v20
v_sub_f32 v126, v126, v20
v_sub_f32 v127, v127, v20
v_sub_f32 v140, v140, v20
v_sub_f32 v141, v141, v20
v_sub_f32 v142, v142, v20
v_sub_f32 v143, v143, v20
v_sub_f32 v156, v156, v20
v_sub_f32 v157, v157, v20
v_sub_f32 v158, v158, v20
v_sub_f32 v159, v159, v20
v_sub_f32 v28, v28, v20
v_sub_f32 v29, v29, v20
v_sub_f32 v30, v30, v20
v_sub_f32 v31, v31, v20
v_mul_f32 v16, v16, v24
v_sub_f32 v48, v48, v21
v_sub_f32 v49, v49, v21
v_sub_f32 v50, v50, v21
v_sub_f32 v51, v51, v21
v_sub_f32 v64, v64, v21
v_sub_f32 v65, v65, v21
v_sub_f32 v66, v66, v21
v_sub_f32 v67, v67, v21
v_sub_f32 v80, v80, v21
v_sub_f32 v81, v81, v21
v_sub_f32 v82, v82, v21
v_sub_f32 v83, v83, v21
v_sub_f32 v96, v96, v21
v_sub_f32 v97, v97, v21
v_sub_f32 v98, v98, v21
v_sub_f32 v99, v99, v21
v_sub_f32 v112, v112, v21
v_sub_f32 v113, v113, v21
v_sub_f32 v114, v114, v21
v_sub_f32 v115, v115, v21
v_sub_f32 v128, v128, v21
v_sub_f32 v129, v129, v21
v_sub_f32 v130, v130, v21
v_sub_f32 v131, v131, v21
v_sub_f32 v144, v144, v21
v_sub_f32 v145, v145, v21
v_sub_f32 v146, v146, v21
v_sub_f32 v147, v147, v21
v_sub_f32 v160, v160, v21
v_sub_f32 v161, v161, v21
v_sub_f32 v162, v162, v21
v_sub_f32 v163, v163, v21
v_sub_f32 v32, v32, v21
v_sub_f32 v33, v33, v21
v_sub_f32 v34, v34, v21
v_sub_f32 v35, v35, v21
v_mul_f32 v17, v17, v25
v_sub_f32 v52, v52, v22
v_sub_f32 v53, v53, v22
v_sub_f32 v54, v54, v22
v_sub_f32 v55, v55, v22
v_sub_f32 v68, v68, v22
v_sub_f32 v69, v69, v22
v_sub_f32 v70, v70, v22
v_sub_f32 v71, v71, v22
v_sub_f32 v84, v84, v22
v_sub_f32 v85, v85, v22
v_sub_f32 v86, v86, v22
v_sub_f32 v87, v87, v22
v_sub_f32 v100, v100, v22
v_sub_f32 v101, v101, v22
v_sub_f32 v102, v102, v22
v_sub_f32 v103, v103, v22
v_sub_f32 v116, v116, v22
v_sub_f32 v117, v117, v22
v_sub_f32 v118, v118, v22
v_sub_f32 v119, v119, v22
v_sub_f32 v132, v132, v22
v_sub_f32 v133, v133, v22
v_sub_f32 v134, v134, v22
v_sub_f32 v135, v135, v22
v_sub_f32 v148, v148, v22
v_sub_f32 v149, v149, v22
v_sub_f32 v150, v150, v22
v_sub_f32 v151, v151, v22
v_sub_f32 v164, v164, v22
v_sub_f32 v165, v165, v22
v_sub_f32 v166, v166, v22
v_sub_f32 v167, v167, v22
v_sub_f32 v36, v36, v22
v_sub_f32 v37, v37, v22
v_sub_f32 v38, v38, v22
v_sub_f32 v39, v39, v22
v_mul_f32 v18, v18, v26
v_sub_f32 v56, v56, v23
v_sub_f32 v57, v57, v23
v_sub_f32 v58, v58, v23
v_sub_f32 v59, v59, v23
v_sub_f32 v72, v72, v23
v_sub_f32 v73, v73, v23
v_sub_f32 v74, v74, v23
v_sub_f32 v75, v75, v23
v_sub_f32 v88, v88, v23
v_sub_f32 v89, v89, v23
v_sub_f32 v90, v90, v23
v_sub_f32 v91, v91, v23
v_sub_f32 v104, v104, v23
v_sub_f32 v105, v105, v23
v_sub_f32 v106, v106, v23
v_sub_f32 v107, v107, v23
v_sub_f32 v120, v120, v23
v_sub_f32 v121, v121, v23
v_sub_f32 v122, v122, v23
v_sub_f32 v123, v123, v23
v_sub_f32 v136, v136, v23
v_sub_f32 v137, v137, v23
v_sub_f32 v138, v138, v23
v_sub_f32 v139, v139, v23
v_sub_f32 v152, v152, v23
v_sub_f32 v153, v153, v23
v_sub_f32 v154, v154, v23
v_sub_f32 v155, v155, v23
v_sub_f32 v168, v168, v23
v_sub_f32 v169, v169, v23
v_sub_f32 v170, v170, v23
v_sub_f32 v171, v171, v23
v_sub_f32 v40, v40, v23
v_sub_f32 v41, v41, v23
v_sub_f32 v42, v42, v23
v_sub_f32 v43, v43, v23
v_mul_f32 v19, v19, v27
ds_bpermute_b32 v242, v4, v24 offset:0
ds_bpermute_b32 v243, v4, v24 offset:4
ds_bpermute_b32 v244, v4, v24 offset:8
ds_bpermute_b32 v245, v4, v24 offset:12
s_waitcnt lgkmcnt(0)
v_accvgpr_read_b32 v20, a0
v_accvgpr_read_b32 v21, a1
v_accvgpr_read_b32 v22, a2
v_accvgpr_read_b32 v23, a3
v_mul_f32 v20, v20, v242
v_mul_f32 v21, v21, v243
v_mul_f32 v22, v22, v244
v_mul_f32 v23, v23, v245
v_accvgpr_write_b32 a0, v20
v_accvgpr_write_b32 a1, v21
v_accvgpr_write_b32 a2, v22
v_accvgpr_write_b32 a3, v23
v_accvgpr_read_b32 v20, a16
v_accvgpr_read_b32 v21, a17
v_accvgpr_read_b32 v22, a18
v_accvgpr_read_b32 v23, a19
v_mul_f32 v20, v20, v242
v_mul_f32 v21, v21, v243
v_mul_f32 v22, v22, v244
v_mul_f32 v23, v23, v245
v_accvgpr_write_b32 a16, v20
v_accvgpr_write_b32 a17, v21
v_accvgpr_write_b32 a18, v22
v_accvgpr_write_b32 a19, v23
v_accvgpr_read_b32 v20, a32
v_accvgpr_read_b32 v21, a33
v_accvgpr_read_b32 v22, a34
v_accvgpr_read_b32 v23, a35
v_mul_f32 v20, v20, v242
v_mul_f32 v21, v21, v243
v_mul_f32 v22, v22, v244
v_mul_f32 v23, v23, v245
v_accvgpr_write_b32 a32, v20
v_accvgpr_write_b32 a33, v21
v_accvgpr_write_b32 a34, v22
v_accvgpr_write_b32 a35, v23
v_accvgpr_read_b32 v20, a48
v_accvgpr_read_b32 v21, a49
v_accvgpr_read_b32 v22, a50
v_accvgpr_read_b32 v23, a51
v_mul_f32 v20, v20, v242
v_mul_f32 v21, v21, v243
v_mul_f32 v22, v22, v244
v_mul_f32 v23, v23, v245
v_accvgpr_write_b32 a48, v20
v_accvgpr_write_b32 a49, v21
v_accvgpr_write_b32 a50, v22
v_accvgpr_write_b32 a51, v23
v_accvgpr_read_b32 v20, a64
v_accvgpr_read_b32 v21, a65
v_accvgpr_read_b32 v22, a66
v_accvgpr_read_b32 v23, a67
v_mul_f32 v20, v20, v242
v_mul_f32 v21, v21, v243
v_mul_f32 v22, v22, v244
v_mul_f32 v23, v23, v245
v_accvgpr_write_b32 a64, v20
v_accvgpr_write_b32 a65, v21
v_accvgpr_write_b32 a66, v22
v_accvgpr_write_b32 a67, v23
v_accvgpr_read_b32 v20, a80
v_accvgpr_read_b32 v21, a81
v_accvgpr_read_b32 v22, a82
v_accvgpr_read_b32 v23, a83
v_mul_f32 v20, v20, v242
v_mul_f32 v21, v21, v243
v_mul_f32 v22, v22, v244
v_mul_f32 v23, v23, v245
v_accvgpr_write_b32 a80, v20
v_accvgpr_write_b32 a81, v21
v_accvgpr_write_b32 a82, v22
v_accvgpr_write_b32 a83, v23
v_accvgpr_read_b32 v20, a96
v_accvgpr_read_b32 v21, a97
v_accvgpr_read_b32 v22, a98
v_accvgpr_read_b32 v23, a99
v_mul_f32 v20, v20, v242
v_mul_f32 v21, v21, v243
v_mul_f32 v22, v22, v244
v_mul_f32 v23, v23, v245
v_accvgpr_write_b32 a96, v20
v_accvgpr_write_b32 a97, v21
v_accvgpr_write_b32 a98, v22
v_accvgpr_write_b32 a99, v23
v_accvgpr_read_b32 v20, a112
v_accvgpr_read_b32 v21, a113
v_accvgpr_read_b32 v22, a114
v_accvgpr_read_b32 v23, a115
v_mul_f32 v20, v20, v242
v_mul_f32 v21, v21, v243
v_mul_f32 v22, v22, v244
v_mul_f32 v23, v23, v245
v_accvgpr_write_b32 a112, v20
v_accvgpr_write_b32 a113, v21
v_accvgpr_write_b32 a114, v22
v_accvgpr_write_b32 a115, v23
ds_bpermute_b32 v242, v4, v25 offset:0
ds_bpermute_b32 v243, v4, v25 offset:4
ds_bpermute_b32 v244, v4, v25 offset:8
ds_bpermute_b32 v245, v4, v25 offset:12
s_waitcnt lgkmcnt(0)
v_accvgpr_read_b32 v20, a4
v_accvgpr_read_b32 v21, a5
v_accvgpr_read_b32 v22, a6
v_accvgpr_read_b32 v23, a7
v_mul_f32 v20, v20, v242
v_mul_f32 v21, v21, v243
v_mul_f32 v22, v22, v244
v_mul_f32 v23, v23, v245
v_accvgpr_write_b32 a4, v20
v_accvgpr_write_b32 a5, v21
v_accvgpr_write_b32 a6, v22
v_accvgpr_write_b32 a7, v23
v_accvgpr_read_b32 v20, a20
v_accvgpr_read_b32 v21, a21
v_accvgpr_read_b32 v22, a22
v_accvgpr_read_b32 v23, a23
v_mul_f32 v20, v20, v242
v_mul_f32 v21, v21, v243
v_mul_f32 v22, v22, v244
v_mul_f32 v23, v23, v245
v_accvgpr_write_b32 a20, v20
v_accvgpr_write_b32 a21, v21
v_accvgpr_write_b32 a22, v22
v_accvgpr_write_b32 a23, v23
v_accvgpr_read_b32 v20, a36
v_accvgpr_read_b32 v21, a37
v_accvgpr_read_b32 v22, a38
v_accvgpr_read_b32 v23, a39
v_mul_f32 v20, v20, v242
v_mul_f32 v21, v21, v243
v_mul_f32 v22, v22, v244
v_mul_f32 v23, v23, v245
v_accvgpr_write_b32 a36, v20
v_accvgpr_write_b32 a37, v21
v_accvgpr_write_b32 a38, v22
v_accvgpr_write_b32 a39, v23
v_accvgpr_read_b32 v20, a52
v_accvgpr_read_b32 v21, a53
v_accvgpr_read_b32 v22, a54
v_accvgpr_read_b32 v23, a55
v_mul_f32 v20, v20, v242
v_mul_f32 v21, v21, v243
v_mul_f32 v22, v22, v244
v_mul_f32 v23, v23, v245
v_accvgpr_write_b32 a52, v20
v_accvgpr_write_b32 a53, v21
v_accvgpr_write_b32 a54, v22
v_accvgpr_write_b32 a55, v23
v_accvgpr_read_b32 v20, a68
v_accvgpr_read_b32 v21, a69
v_accvgpr_read_b32 v22, a70
v_accvgpr_read_b32 v23, a71
v_mul_f32 v20, v20, v242
v_mul_f32 v21, v21, v243
v_mul_f32 v22, v22, v244
v_mul_f32 v23, v23, v245
v_accvgpr_write_b32 a68, v20
v_accvgpr_write_b32 a69, v21
v_accvgpr_write_b32 a70, v22
v_accvgpr_write_b32 a71, v23
v_accvgpr_read_b32 v20, a84
v_accvgpr_read_b32 v21, a85
v_accvgpr_read_b32 v22, a86
v_accvgpr_read_b32 v23, a87
v_mul_f32 v20, v20, v242
v_mul_f32 v21, v21, v243
v_mul_f32 v22, v22, v244
v_mul_f32 v23, v23, v245
v_accvgpr_write_b32 a84, v20
v_accvgpr_write_b32 a85, v21
v_accvgpr_write_b32 a86, v22
v_accvgpr_write_b32 a87, v23
v_accvgpr_read_b32 v20, a100
v_accvgpr_read_b32 v21, a101
v_accvgpr_read_b32 v22, a102
v_accvgpr_read_b32 v23, a103
v_mul_f32 v20, v20, v242
v_mul_f32 v21, v21, v243
v_mul_f32 v22, v22, v244
v_mul_f32 v23, v23, v245
v_accvgpr_write_b32 a100, v20
v_accvgpr_write_b32 a101, v21
v_accvgpr_write_b32 a102, v22
v_accvgpr_write_b32 a103, v23
v_accvgpr_read_b32 v20, a116
v_accvgpr_read_b32 v21, a117
v_accvgpr_read_b32 v22, a118
v_accvgpr_read_b32 v23, a119
v_mul_f32 v20, v20, v242
v_mul_f32 v21, v21, v243
v_mul_f32 v22, v22, v244
v_mul_f32 v23, v23, v245
v_accvgpr_write_b32 a116, v20
v_accvgpr_write_b32 a117, v21
v_accvgpr_write_b32 a118, v22
v_accvgpr_write_b32 a119, v23
ds_bpermute_b32 v242, v4, v26 offset:0
ds_bpermute_b32 v243, v4, v26 offset:4
ds_bpermute_b32 v244, v4, v26 offset:8
ds_bpermute_b32 v245, v4, v26 offset:12
s_waitcnt lgkmcnt(0)
v_accvgpr_read_b32 v20, a8
v_accvgpr_read_b32 v21, a9
v_accvgpr_read_b32 v22, a10
v_accvgpr_read_b32 v23, a11
v_mul_f32 v20, v20, v242
v_mul_f32 v21, v21, v243
v_mul_f32 v22, v22, v244
v_mul_f32 v23, v23, v245
v_accvgpr_write_b32 a8, v20
v_accvgpr_write_b32 a9, v21
v_accvgpr_write_b32 a10, v22
v_accvgpr_write_b32 a11, v23
v_accvgpr_read_b32 v20, a24
v_accvgpr_read_b32 v21, a25
v_accvgpr_read_b32 v22, a26
v_accvgpr_read_b32 v23, a27
v_mul_f32 v20, v20, v242
v_mul_f32 v21, v21, v243
v_mul_f32 v22, v22, v244
v_mul_f32 v23, v23, v245
v_accvgpr_write_b32 a24, v20
v_accvgpr_write_b32 a25, v21
v_accvgpr_write_b32 a26, v22
v_accvgpr_write_b32 a27, v23
v_accvgpr_read_b32 v20, a40
v_accvgpr_read_b32 v21, a41
v_accvgpr_read_b32 v22, a42
v_accvgpr_read_b32 v23, a43
v_mul_f32 v20, v20, v242
v_mul_f32 v21, v21, v243
v_mul_f32 v22, v22, v244
v_mul_f32 v23, v23, v245
v_accvgpr_write_b32 a40, v20
v_accvgpr_write_b32 a41, v21
v_accvgpr_write_b32 a42, v22
v_accvgpr_write_b32 a43, v23
v_accvgpr_read_b32 v20, a56
v_accvgpr_read_b32 v21, a57
v_accvgpr_read_b32 v22, a58
v_accvgpr_read_b32 v23, a59
v_mul_f32 v20, v20, v242
v_mul_f32 v21, v21, v243
v_mul_f32 v22, v22, v244
v_mul_f32 v23, v23, v245
v_accvgpr_write_b32 a56, v20
v_accvgpr_write_b32 a57, v21
v_accvgpr_write_b32 a58, v22
v_accvgpr_write_b32 a59, v23
v_accvgpr_read_b32 v20, a72
v_accvgpr_read_b32 v21, a73
v_accvgpr_read_b32 v22, a74
v_accvgpr_read_b32 v23, a75
v_mul_f32 v20, v20, v242
v_mul_f32 v21, v21, v243
v_mul_f32 v22, v22, v244
v_mul_f32 v23, v23, v245
v_accvgpr_write_b32 a72, v20
v_accvgpr_write_b32 a73, v21
v_accvgpr_write_b32 a74, v22
v_accvgpr_write_b32 a75, v23
v_accvgpr_read_b32 v20, a88
v_accvgpr_read_b32 v21, a89
v_accvgpr_read_b32 v22, a90
v_accvgpr_read_b32 v23, a91
v_mul_f32 v20, v20, v242
v_mul_f32 v21, v21, v243
v_mul_f32 v22, v22, v244
v_mul_f32 v23, v23, v245
v_accvgpr_write_b32 a88, v20
v_accvgpr_write_b32 a89, v21
v_accvgpr_write_b32 a90, v22
v_accvgpr_write_b32 a91, v23
v_accvgpr_read_b32 v20, a104
v_accvgpr_read_b32 v21, a105
v_accvgpr_read_b32 v22, a106
v_accvgpr_read_b32 v23, a107
v_mul_f32 v20, v20, v242
v_mul_f32 v21, v21, v243
v_mul_f32 v22, v22, v244
v_mul_f32 v23, v23, v245
v_accvgpr_write_b32 a104, v20
v_accvgpr_write_b32 a105, v21
v_accvgpr_write_b32 a106, v22
v_accvgpr_write_b32 a107, v23
v_accvgpr_read_b32 v20, a120
v_accvgpr_read_b32 v21, a121
v_accvgpr_read_b32 v22, a122
v_accvgpr_read_b32 v23, a123
v_mul_f32 v20, v20, v242
v_mul_f32 v21, v21, v243
v_mul_f32 v22, v22, v244
v_mul_f32 v23, v23, v245
v_accvgpr_write_b32 a120, v20
v_accvgpr_write_b32 a121, v21
v_accvgpr_write_b32 a122, v22
v_accvgpr_write_b32 a123, v23
ds_bpermute_b32 v242, v4, v27 offset:0
ds_bpermute_b32 v243, v4, v27 offset:4
ds_bpermute_b32 v244, v4, v27 offset:8
ds_bpermute_b32 v245, v4, v27 offset:12
s_waitcnt lgkmcnt(0)
v_accvgpr_read_b32 v20, a12
v_accvgpr_read_b32 v21, a13
v_accvgpr_read_b32 v22, a14
v_accvgpr_read_b32 v23, a15
v_mul_f32 v20, v20, v242
v_mul_f32 v21, v21, v243
v_mul_f32 v22, v22, v244
v_mul_f32 v23, v23, v245
v_accvgpr_write_b32 a12, v20
v_accvgpr_write_b32 a13, v21
v_accvgpr_write_b32 a14, v22
v_accvgpr_write_b32 a15, v23
v_accvgpr_read_b32 v20, a28
v_accvgpr_read_b32 v21, a29
v_accvgpr_read_b32 v22, a30
v_accvgpr_read_b32 v23, a31
v_mul_f32 v20, v20, v242
v_mul_f32 v21, v21, v243
v_mul_f32 v22, v22, v244
v_mul_f32 v23, v23, v245
v_accvgpr_write_b32 a28, v20
v_accvgpr_write_b32 a29, v21
v_accvgpr_write_b32 a30, v22
v_accvgpr_write_b32 a31, v23
v_accvgpr_read_b32 v20, a44
v_accvgpr_read_b32 v21, a45
v_accvgpr_read_b32 v22, a46
v_accvgpr_read_b32 v23, a47
v_mul_f32 v20, v20, v242
v_mul_f32 v21, v21, v243
v_mul_f32 v22, v22, v244
v_mul_f32 v23, v23, v245
v_accvgpr_write_b32 a44, v20
v_accvgpr_write_b32 a45, v21
v_accvgpr_write_b32 a46, v22
v_accvgpr_write_b32 a47, v23
v_accvgpr_read_b32 v20, a60
v_accvgpr_read_b32 v21, a61
v_accvgpr_read_b32 v22, a62
v_accvgpr_read_b32 v23, a63
v_mul_f32 v20, v20, v242
v_mul_f32 v21, v21, v243
v_mul_f32 v22, v22, v244
v_mul_f32 v23, v23, v245
v_accvgpr_write_b32 a60, v20
v_accvgpr_write_b32 a61, v21
v_accvgpr_write_b32 a62, v22
v_accvgpr_write_b32 a63, v23
v_accvgpr_read_b32 v20, a76
v_accvgpr_read_b32 v21, a77
v_accvgpr_read_b32 v22, a78
v_accvgpr_read_b32 v23, a79
v_mul_f32 v20, v20, v242
v_mul_f32 v21, v21, v243
v_mul_f32 v22, v22, v244
v_mul_f32 v23, v23, v245
v_accvgpr_write_b32 a76, v20
v_accvgpr_write_b32 a77, v21
v_accvgpr_write_b32 a78, v22
v_accvgpr_write_b32 a79, v23
v_accvgpr_read_b32 v20, a92
v_accvgpr_read_b32 v21, a93
v_accvgpr_read_b32 v22, a94
v_accvgpr_read_b32 v23, a95
v_mul_f32 v20, v20, v242
v_mul_f32 v21, v21, v243
v_mul_f32 v22, v22, v244
v_mul_f32 v23, v23, v245
v_accvgpr_write_b32 a92, v20
v_accvgpr_write_b32 a93, v21
v_accvgpr_write_b32 a94, v22
v_accvgpr_write_b32 a95, v23
v_accvgpr_read_b32 v20, a108
v_accvgpr_read_b32 v21, a109
v_accvgpr_read_b32 v22, a110
v_accvgpr_read_b32 v23, a111
v_mul_f32 v20, v20, v242
v_mul_f32 v21, v21, v243
v_mul_f32 v22, v22, v244
v_mul_f32 v23, v23, v245
v_accvgpr_write_b32 a108, v20
v_accvgpr_write_b32 a109, v21
v_accvgpr_write_b32 a110, v22
v_accvgpr_write_b32 a111, v23
v_accvgpr_read_b32 v20, a124
v_accvgpr_read_b32 v21, a125
v_accvgpr_read_b32 v22, a126
v_accvgpr_read_b32 v23, a127
v_mul_f32 v20, v20, v242
v_mul_f32 v21, v21, v243
v_mul_f32 v22, v22, v244
v_mul_f32 v23, v23, v245
v_accvgpr_write_b32 a124, v20
v_accvgpr_write_b32 a125, v21
v_accvgpr_write_b32 a126, v22
v_accvgpr_write_b32 a127, v23
v_exp_f32 v20, v108
v_exp_f32 v21, v109
v_exp_f32 v22, v110
v_exp_f32 v23, v111
v_add_f32 v12, v20, v21
v_cvt_pk_bf16_f32 v204, v20, v21
v_exp_f32 v24, v112
v_exp_f32 v25, v113
v_add_f32 v12, v12, v22
v_add_f32 v12, v12, v23
v_cvt_pk_bf16_f32 v205, v22, v23
v_exp_f32 v26, v114
v_exp_f32 v27, v115
v_add_f32 v13, v24, v25
v_cvt_pk_bf16_f32 v208, v24, v25
v_exp_f32 v20, v116
v_exp_f32 v21, v117
v_add_f32 v13, v13, v26
v_add_f32 v13, v13, v27
v_cvt_pk_bf16_f32 v209, v26, v27
v_exp_f32 v22, v118
v_exp_f32 v23, v119
v_add_f32 v14, v20, v21
v_cvt_pk_bf16_f32 v212, v20, v21
v_exp_f32 v24, v120
v_exp_f32 v25, v121
v_add_f32 v14, v14, v22
v_add_f32 v14, v14, v23
v_cvt_pk_bf16_f32 v213, v22, v23
v_exp_f32 v26, v122
v_exp_f32 v27, v123
v_add_f32 v15, v24, v25
v_cvt_pk_bf16_f32 v216, v24, v25
v_exp_f32 v20, v124
v_exp_f32 v21, v125
v_add_f32 v15, v15, v26
v_add_f32 v15, v15, v27
v_cvt_pk_bf16_f32 v217, v26, v27
v_exp_f32 v22, v126
v_exp_f32 v23, v127
v_add_f32 v12, v12, v20
v_add_f32 v12, v12, v21
v_cvt_pk_bf16_f32 v206, v20, v21
v_exp_f32 v24, v128
v_exp_f32 v25, v129
v_add_f32 v12, v12, v22
v_add_f32 v12, v12, v23
v_cvt_pk_bf16_f32 v207, v22, v23
v_exp_f32 v26, v130
v_exp_f32 v27, v131
v_add_f32 v13, v13, v24
v_add_f32 v13, v13, v25
v_cvt_pk_bf16_f32 v210, v24, v25
v_exp_f32 v20, v132
v_exp_f32 v21, v133
v_add_f32 v13, v13, v26
v_add_f32 v13, v13, v27
v_cvt_pk_bf16_f32 v211, v26, v27
v_exp_f32 v22, v134
v_exp_f32 v23, v135
v_add_f32 v14, v14, v20
v_add_f32 v14, v14, v21
v_cvt_pk_bf16_f32 v214, v20, v21
v_exp_f32 v24, v136
v_exp_f32 v25, v137
v_add_f32 v14, v14, v22
v_add_f32 v14, v14, v23
v_cvt_pk_bf16_f32 v215, v22, v23
v_exp_f32 v26, v138
v_exp_f32 v27, v139
v_add_f32 v15, v15, v24
v_add_f32 v15, v15, v25
v_cvt_pk_bf16_f32 v218, v24, v25
v_exp_f32 v20, v140
v_exp_f32 v21, v141
v_add_f32 v15, v15, v26
v_add_f32 v15, v15, v27
v_cvt_pk_bf16_f32 v219, v26, v27
v_exp_f32 v22, v142
v_exp_f32 v23, v143
v_add_f32 v12, v12, v20
v_add_f32 v12, v12, v21
v_cvt_pk_bf16_f32 v220, v20, v21
v_exp_f32 v24, v144
v_exp_f32 v25, v145
v_add_f32 v12, v12, v22
v_add_f32 v12, v12, v23
v_cvt_pk_bf16_f32 v221, v22, v23
v_exp_f32 v26, v146
v_exp_f32 v27, v147
v_add_f32 v13, v13, v24
v_add_f32 v13, v13, v25
v_cvt_pk_bf16_f32 v224, v24, v25
v_exp_f32 v20, v148
v_exp_f32 v21, v149
v_add_f32 v13, v13, v26
v_add_f32 v13, v13, v27
v_cvt_pk_bf16_f32 v225, v26, v27
v_exp_f32 v22, v150
v_exp_f32 v23, v151
v_add_f32 v14, v14, v20
v_add_f32 v14, v14, v21
v_cvt_pk_bf16_f32 v228, v20, v21
v_exp_f32 v24, v152
v_exp_f32 v25, v153
v_add_f32 v14, v14, v22
v_add_f32 v14, v14, v23
v_cvt_pk_bf16_f32 v229, v22, v23
v_exp_f32 v26, v154
v_exp_f32 v27, v155
v_add_f32 v15, v15, v24
v_add_f32 v15, v15, v25
v_cvt_pk_bf16_f32 v232, v24, v25
v_exp_f32 v20, v156
v_exp_f32 v21, v157
v_add_f32 v15, v15, v26
v_add_f32 v15, v15, v27
v_cvt_pk_bf16_f32 v233, v26, v27
v_exp_f32 v22, v158
v_exp_f32 v23, v159
v_add_f32 v12, v12, v20
v_add_f32 v12, v12, v21
v_cvt_pk_bf16_f32 v222, v20, v21
v_exp_f32 v24, v160
v_exp_f32 v25, v161
v_add_f32 v12, v12, v22
v_add_f32 v12, v12, v23
v_cvt_pk_bf16_f32 v223, v22, v23
v_exp_f32 v26, v162
v_exp_f32 v27, v163
v_add_f32 v13, v13, v24
v_add_f32 v13, v13, v25
v_cvt_pk_bf16_f32 v226, v24, v25
v_exp_f32 v20, v164
v_exp_f32 v21, v165
v_add_f32 v13, v13, v26
v_add_f32 v13, v13, v27
v_cvt_pk_bf16_f32 v227, v26, v27
v_exp_f32 v22, v166
v_exp_f32 v23, v167
v_add_f32 v14, v14, v20
v_add_f32 v14, v14, v21
v_cvt_pk_bf16_f32 v230, v20, v21
v_exp_f32 v24, v168
v_exp_f32 v25, v169
v_add_f32 v14, v14, v22
v_add_f32 v14, v14, v23
v_cvt_pk_bf16_f32 v231, v22, v23
v_exp_f32 v26, v170
v_exp_f32 v27, v171
v_add_f32 v15, v15, v24
v_add_f32 v15, v15, v25
v_cvt_pk_bf16_f32 v234, v24, v25
s_nop 0
v_add_f32 v15, v15, v26
v_add_f32 v15, v15, v27
v_cvt_pk_bf16_f32 v235, v26, v27
s_nop 0
v_exp_f32 v20, v44
s_nop 0
v_exp_f32 v21, v45
s_nop 0
v_exp_f32 v22, v46
s_nop 0
v_add_f32 v8, v20, v21
s_nop 0
v_exp_f32 v23, v47
s_nop 0
v_cvt_pk_bf16_f32 v172, v20, v21
s_nop 0
v_exp_f32 v24, v48
s_nop 0
v_add_f32 v8, v8, v22
s_nop 0
v_add_f32 v8, v8, v23
s_nop 0
v_exp_f32 v25, v49
s_nop 0
v_cvt_pk_bf16_f32 v173, v22, v23
s_nop 3
s_setpc_b64 s[22:23]
.section .rodata,"a"
.p2align 6
.amdhsa_kernel standalone__kv_cache_quant_int4_int2_kv_with_per_channel_or_per_token_scales__prompt_kernel
  .amdhsa_next_free_vgpr 508
  .amdhsa_next_free_sgpr 102
  .amdhsa_accum_offset 252
  .amdhsa_group_segment_fixed_size 0
  .amdhsa_kernarg_size 80
  .amdhsa_user_sgpr_count 2
  .amdhsa_user_sgpr_kernarg_segment_ptr 1
  .amdhsa_system_sgpr_workgroup_id_x 1
  .amdhsa_float_denorm_mode_32 3
.end_amdhsa_kernel
```
